```python
import torch

def _softmax(x, axis=-1):
    return torch.softmax(x, dim=axis)
def _gelu(x):
    return torch.nn.functional.gelu(x, approximate="tanh")
def _silu(x):
    return torch.nn.functional.silu(x)
def _sigmoid(x):
    return torch.sigmoid(x)
def _layernorm(x, axis=-1, eps=1e-5):
    m = x.mean(dim=axis, keepdim=True)
    v = x.var(dim=axis, keepdim=True, unbiased=False)
    return (x - m) / torch.sqrt(v + eps)
def _scatter_add(tgt, idx, src, axis=0):
    return tgt.clone().index_add_(axis, idx, src)
def _segment_sum(src, seg, n):
    out = torch.zeros((n,) + src.shape[1:], dtype=src.dtype)
    return out.index_add_(0, seg, src)
def _pad(x, pw):
    flat = tuple(v for pair in reversed(pw) for v in pair)
    return torch.nn.functional.pad(x, flat)

kernel_name = 'parallel_sum__sliding_block_cached__swiglu_ffn__decode'

def setup_inputs():

    _w = (lambda a: (lambda t: t.to(torch.bfloat16) if t.is_floating_point() else t)(torch.as_tensor(a)))
    def _A_setup():
        B, Sq, D = 2, 1, 512
        Hq, Hkv, Sk, Dh = 32, 8, 32768, 128
        assert Hq % Hkv == 0, (Hq, Hkv)
        return {
            "x": _w((lambda *s: torch.randn(*s, dtype=torch.bfloat16) * 0.05)(B, Sq, D)),
            "k_cache": _w((lambda *s: torch.randn(*s, dtype=torch.bfloat16) * 3.2)(B, Hkv, Sk, Dh)),
            "v_cache": _w((lambda *s: torch.randn(*s, dtype=torch.bfloat16) * 1.6)(B, Hkv, Sk, Dh)),
            "wq": _w((lambda *s: torch.randn(*s, dtype=torch.bfloat16) * 3.2)(D, Hq * Dh) * (D ** -0.5)),
            "wo": _w((lambda *s: torch.randn(*s, dtype=torch.bfloat16) * 1.6)(Hq * Dh, D) * ((Hq * Dh) ** -0.5)),
        }
    _A_in = _A_setup()

    def _B_setup():
        B, S, D, F = 2, 1, 512, 1792
        return {
            "x": _w((lambda *s: torch.randn(*s, dtype=torch.bfloat16) * 0.05)(B, S, D)),
            "w_gate": _w((lambda *s: torch.randn(*s, dtype=torch.bfloat16) * 0.05)(D, F)),
            "w_up": _w((lambda *s: torch.randn(*s, dtype=torch.bfloat16) * 0.05)(D, F)),
            "w_down": _w((lambda *s: torch.randn(*s, dtype=torch.bfloat16) * 0.05)(F, D)),
        }
    _B_in = _B_setup()

    return {
        "A_x": _A_in["x"],
        "A_k_cache": _A_in["k_cache"],
        "A_v_cache": _A_in["v_cache"],
        "A_wq": _A_in["wq"],
        "A_wo": _A_in["wo"],
        "B_x": _B_in["x"],
        "B_w_gate": _B_in["w_gate"],
        "B_w_up": _B_in["w_up"],
        "B_w_down": _B_in["w_down"],
    }

def reference(A_x, A_k_cache, A_v_cache, A_wq, A_wo, B_x, B_w_gate, B_w_up, B_w_down):
    def _A_ref(x, k_cache, v_cache, wq, wo):
        B, Sq, D = x.shape
        Hq, Dh = 32, 128
        Hkv, Sk = k_cache.shape[1], k_cache.shape[2]
        W = min(4096, max(256, Sk // 4))
        rep = Hq // Hkv
        q = (lambda x, *d: x.permute(*d))((x @ wq).reshape(B, Sq, Hq, Dh), 0, 2, 1, 3)
        k = (lambda x, n, axis: torch.repeat_interleave(x, n, dim=axis))(k_cache[:, :, Sk - W:, :], rep, axis=1)
        v = (lambda x, n, axis: torch.repeat_interleave(x, n, dim=axis))(v_cache[:, :, Sk - W:, :], rep, axis=1)
        scores = torch.einsum("bhqd,bhkd->bhqk", q, k) * (Dh ** -0.5)
        p = _softmax(scores, axis=-1)
        o = torch.einsum("bhqk,bhkd->bhqd", p, v)
        return (lambda x, *d: x.permute(*d))(o, 0, 2, 1, 3).reshape(B, Sq, Hq * Dh) @ wo

    def _B_ref(x, w_gate, w_up, w_down):
        g = _silu(x @ w_gate)
        u = x @ w_up
        return (g * u) @ w_down

    x = A_x
    xn = _layernorm(x, axis=-1)
    return x + _A_ref(xn, A_k_cache, A_v_cache, A_wq, A_wo) + _B_ref(xn, B_w_gate, B_w_up, B_w_down)
```

```asm
; @launch grid=(256,1,1) block=(512,1,1) lds=153664
.amdgcn_target "amdgcn-amd-amdhsa--gfx950"
.text
.globl parallel_sum__sliding_block_cached__swiglu_ffn__decode_kernel
.p2align 8
.type parallel_sum__sliding_block_cached__swiglu_ffn__decode_kernel,@function
parallel_sum__sliding_block_cached__swiglu_ffn__decode_kernel:
    s_cmp_ge_u32 s2, 256
    s_cbranch_scc1 L_end
    s_load_dwordx16 s[16:31], s[0:1], 0
    s_load_dwordx8 s[32:39], s[0:1], 64
    s_memrealtime s[92:93]
    v_lshrrev_b32 v1, 6, v0
    v_and_b32 v0, 63, v0
    v_mov_b32 v15, 0xff
    v_readfirstlane_b32 s3, v1
    s_waitcnt lgkmcnt(0)
    s_mov_b32 s44, s18
    s_and_b32 s45, s19, 0xffff
    s_mov_b32 s46, 134217728
    s_mov_b32 s47, 0x20000
    s_mov_b32 s48, s20
    s_and_b32 s49, s21, 0xffff
    s_mov_b32 s50, 134217728
    s_mov_b32 s51, 0x20000
    s_mov_b32 s80, s38
    s_and_b32 s81, s39, 0xffff
    s_mov_b32 s82, 1294336
    s_mov_b32 s83, 0x20000
    v_mov_b32 v16, 0
    v_mov_b32 v17, 153088
    ds_write_b32 v17, v16
    s_waitcnt lgkmcnt(0)
    s_barrier
    s_cmp_ge_u32 s3, 4
    s_cbranch_scc1 L_stream
    s_mov_b32 s40, s16
    s_and_b32 s41, s17, 0xffff
    s_mov_b32 s42, 2048
    s_mov_b32 s43, 0x20000
    s_mov_b32 s52, s22
    s_and_b32 s53, s23, 0xffff
    s_mov_b32 s54, 4194304
    s_mov_b32 s55, 0x20000
    s_mov_b32 s56, s24
    s_and_b32 s57, s25, 0xffff
    s_mov_b32 s58, 4194304
    s_mov_b32 s59, 0x20000
    s_mov_b32 s60, s28
    s_and_b32 s61, s29, 0xffff
    s_mov_b32 s62, 1835008
    s_mov_b32 s63, 0x20000
    s_mov_b32 s64, s30
    s_and_b32 s65, s31, 0xffff
    s_mov_b32 s66, 1835008
    s_mov_b32 s67, 0x20000
    s_mov_b32 s68, s32
    s_and_b32 s69, s33, 0xffff
    s_mov_b32 s70, 1835008
    s_mov_b32 s71, 0x20000
    s_mov_b32 s72, s34
    s_and_b32 s73, s35, 0xffff
    s_mov_b32 s74, 2048
    s_mov_b32 s75, 0x20000
    s_mov_b32 s76, s36
    s_and_b32 s77, s37, 0xffff
    s_mov_b32 s78, 256
    s_mov_b32 s79, 0x20000
L_aux:
    v_lshlrev_b32 v1, 4, v0
    buffer_load_dwordx4 v[2:5], v1, s[40:43], 0 offen
    buffer_load_dwordx4 v[6:9], v1, s[40:43], 0 offen offset:1024
    s_cmp_lg_u32 s3, 3
    s_cbranch_scc1 L_aux_nn
    v_mov_b32 v14, 0
    s_mov_b32 s14, 0
    s_cmp_ge_u32 s2, 8
    s_cbranch_scc1 L_nonce
    s_or_b32 s92, s92, 1
    v_mov_b32 v16, s92
    v_mov_b32 v17, 0
    s_mov_b64 exec, 1
    buffer_atomic_cmpswap v[16:17], v14, s[76:79], 0 offen sc0 sc1
    s_mov_b64 exec, -1
    s_waitcnt vmcnt(0)
    v_readfirstlane_b32 s93, v16
    s_nop 3
    s_cmp_eq_u32 s93, 0
    s_cselect_b32 s92, s92, s93
    s_branch L_nonce_ok
L_nonce:
    buffer_load_dword v16, v14, s[76:79], 0 offen sc1
    s_waitcnt vmcnt(0)
    v_readfirstlane_b32 s92, v16
    s_nop 3
    s_cmp_lg_u32 s92, 0
    s_cbranch_scc1 L_nonce_ok
    s_add_u32 s14, s14, 1
    s_cmp_lt_u32 s14, 400000
    s_cbranch_scc1 L_nonce
L_nonce_ok:
    v_mov_b32 v16, s92
    v_mov_b32 v17, 153088
    ds_write_b32 v17, v16
L_aux_nn:
    s_lshl_b32 s11, s3, 12
    s_add_u32 s11, s11, 135168
    s_cmp_ge_u32 s3, 2
    s_cbranch_scc1 L_aux_gu
    s_mov_b32 s84, s52
    s_mov_b32 s85, s53
    s_mov_b32 s86, 4194304
    s_mov_b32 s87, 0x20000
    s_mov_b32 s4, 8192
    s_and_b32 s88, s2, 3
    s_lshl_b32 s88, s88, 1
    s_add_u32 s88, s88, s3
    s_lshl_b32 s5, s88, 6
    s_lshr_b32 s89, s2, 2
    s_lshl_b32 s6, s89, 7
    s_mov_b32 s12, 32768
    s_and_b32 s13, s2, 3
    s_lshl_b32 s13, s13, 16
    s_lshl_b32 s89, s89, 9
    s_add_u32 s13, s13, s89
    s_add_u32 s13, s13, 0
    s_branch L_aux_tile
L_aux_gu:
    s_cmp_eq_u32 s3, 2
    s_cselect_b32 s84, s60, s64
    s_cselect_b32 s85, s61, s65
    s_mov_b32 s86, 1835008
    s_mov_b32 s87, 0x20000
    s_mov_b32 s4, 3584
    s_and_b32 s88, s2, 7
    s_lshl_b32 s5, s88, 6
    s_lshr_b32 s89, s2, 3
    s_lshl_b32 s6, s89, 7
    s_mov_b32 s12, 14336
    s_mul_i32 s13, s88, 28672
    s_lshl_b32 s89, s89, 8
    s_add_u32 s13, s13, s89
    s_sub_u32 s89, s3, 2
    s_mul_i32 s89, s89, 7168
    s_add_u32 s13, s13, s89
    s_add_u32 s13, s13, 262144
L_aux_tile:
    v_lshrrev_b32 v10, 3, v0
    v_and_b32 v11, 7, v0
    v_mul_lo_u32 v12, v10, s4
    v_lshl_add_u32 v12, v11, 4, v12
    s_mul_i32 s7, s5, s4
    s_add_u32 s7, s7, s6
    s_lshl_b32 s8, s4, 3
    s_cmp_ge_u32 s3, 2
    s_cbranch_scc1 L_aux_late
    buffer_load_dwordx4 v[64:67], v12, s[84:87], s7 offen nt
    s_add_u32 s7, s7, s8
    buffer_load_dwordx4 v[68:71], v12, s[84:87], s7 offen nt
    s_add_u32 s7, s7, s8
    buffer_load_dwordx4 v[72:75], v12, s[84:87], s7 offen nt
    s_add_u32 s7, s7, s8
    buffer_load_dwordx4 v[76:79], v12, s[84:87], s7 offen nt
    s_add_u32 s7, s7, s8
    buffer_load_dwordx4 v[80:83], v12, s[84:87], s7 offen nt
    s_add_u32 s7, s7, s8
    buffer_load_dwordx4 v[84:87], v12, s[84:87], s7 offen nt
    s_add_u32 s7, s7, s8
    buffer_load_dwordx4 v[88:91], v12, s[84:87], s7 offen nt
    s_add_u32 s7, s7, s8
    buffer_load_dwordx4 v[92:95], v12, s[84:87], s7 offen nt
    s_waitcnt vmcnt(8)
    s_branch L_aux_ln
L_aux_late:
    s_waitcnt vmcnt(0)
L_aux_ln:
    v_lshlrev_b32 v20, 16, v2
    v_and_b32 v21, 0xffff0000, v2
    v_lshlrev_b32 v28, 16, v6
    v_and_b32 v29, 0xffff0000, v6
    v_lshlrev_b32 v22, 16, v3
    v_and_b32 v23, 0xffff0000, v3
    v_lshlrev_b32 v30, 16, v7
    v_and_b32 v31, 0xffff0000, v7
    v_lshlrev_b32 v24, 16, v4
    v_and_b32 v25, 0xffff0000, v4
    v_lshlrev_b32 v32, 16, v8
    v_and_b32 v33, 0xffff0000, v8
    v_lshlrev_b32 v26, 16, v5
    v_and_b32 v27, 0xffff0000, v5
    v_lshlrev_b32 v34, 16, v9
    v_and_b32 v35, 0xffff0000, v9
    v_add_f32 v36, v20, v21
    v_add_f32 v36, v36, v22
    v_add_f32 v36, v36, v23
    v_add_f32 v36, v36, v24
    v_add_f32 v36, v36, v25
    v_add_f32 v36, v36, v26
    v_add_f32 v36, v36, v27
    v_add_f32 v37, v28, v29
    v_add_f32 v37, v37, v30
    v_add_f32 v37, v37, v31
    v_add_f32 v37, v37, v32
    v_add_f32 v37, v37, v33
    v_add_f32 v37, v37, v34
    v_add_f32 v37, v37, v35
    s_nop 1
    v_add_f32_dpp v36, v36, v36 quad_perm:[1,0,3,2] row_mask:0xf bank_mask:0xf
    v_add_f32_dpp v37, v37, v37 quad_perm:[1,0,3,2] row_mask:0xf bank_mask:0xf
    s_nop 1
    v_add_f32_dpp v36, v36, v36 quad_perm:[2,3,0,1] row_mask:0xf bank_mask:0xf
    v_add_f32_dpp v37, v37, v37 quad_perm:[2,3,0,1] row_mask:0xf bank_mask:0xf
    s_nop 1
    v_add_f32_dpp v36, v36, v36 row_half_mirror row_mask:0xf bank_mask:0xf
    v_add_f32_dpp v37, v37, v37 row_half_mirror row_mask:0xf bank_mask:0xf
    s_nop 1
    v_add_f32_dpp v36, v36, v36 row_mirror row_mask:0xf bank_mask:0xf
    v_add_f32_dpp v37, v37, v37 row_mirror row_mask:0xf bank_mask:0xf
    v_mov_b32 v38, v36
    v_mov_b32 v39, v37
    s_nop 1
    v_permlane16_swap_b32 v36, v38
    v_permlane16_swap_b32 v37, v39
    s_nop 1
    v_add_f32 v36, v36, v38
    v_add_f32 v37, v37, v39
    v_mov_b32 v38, v36
    v_mov_b32 v39, v37
    s_nop 1
    v_permlane32_swap_b32 v36, v38
    v_permlane32_swap_b32 v37, v39
    s_nop 1
    v_add_f32 v36, v36, v38
    v_add_f32 v37, v37, v39
    s_mov_b32 s88, 0x3b000000
    v_mul_f32 v36, s88, v36
    v_mul_f32 v37, s88, v37
    v_sub_f32 v42, v20, v36
    v_mul_f32 v40, v42, v42
    v_sub_f32 v42, v21, v36
    v_fmac_f32 v40, v42, v42
    v_sub_f32 v42, v22, v36
    v_fmac_f32 v40, v42, v42
    v_sub_f32 v42, v23, v36
    v_fmac_f32 v40, v42, v42
    v_sub_f32 v42, v24, v36
    v_fmac_f32 v40, v42, v42
    v_sub_f32 v42, v25, v36
    v_fmac_f32 v40, v42, v42
    v_sub_f32 v42, v26, v36
    v_fmac_f32 v40, v42, v42
    v_sub_f32 v42, v27, v36
    v_fmac_f32 v40, v42, v42
    v_sub_f32 v42, v28, v37
    v_mul_f32 v41, v42, v42
    v_sub_f32 v42, v29, v37
    v_fmac_f32 v41, v42, v42
    v_sub_f32 v42, v30, v37
    v_fmac_f32 v41, v42, v42
    v_sub_f32 v42, v31, v37
    v_fmac_f32 v41, v42, v42
    v_sub_f32 v42, v32, v37
    v_fmac_f32 v41, v42, v42
    v_sub_f32 v42, v33, v37
    v_fmac_f32 v41, v42, v42
    v_sub_f32 v42, v34, v37
    v_fmac_f32 v41, v42, v42
    v_sub_f32 v42, v35, v37
    v_fmac_f32 v41, v42, v42
    s_nop 1
    v_add_f32_dpp v40, v40, v40 quad_perm:[1,0,3,2] row_mask:0xf bank_mask:0xf
    v_add_f32_dpp v41, v41, v41 quad_perm:[1,0,3,2] row_mask:0xf bank_mask:0xf
    s_nop 1
    v_add_f32_dpp v40, v40, v40 quad_perm:[2,3,0,1] row_mask:0xf bank_mask:0xf
    v_add_f32_dpp v41, v41, v41 quad_perm:[2,3,0,1] row_mask:0xf bank_mask:0xf
    s_nop 1
    v_add_f32_dpp v40, v40, v40 row_half_mirror row_mask:0xf bank_mask:0xf
    v_add_f32_dpp v41, v41, v41 row_half_mirror row_mask:0xf bank_mask:0xf
    s_nop 1
    v_add_f32_dpp v40, v40, v40 row_mirror row_mask:0xf bank_mask:0xf
    v_add_f32_dpp v41, v41, v41 row_mirror row_mask:0xf bank_mask:0xf
    v_mov_b32 v38, v40
    v_mov_b32 v39, v41
    s_nop 1
    v_permlane16_swap_b32 v40, v38
    v_permlane16_swap_b32 v41, v39
    s_nop 1
    v_add_f32 v40, v40, v38
    v_add_f32 v41, v41, v39
    v_mov_b32 v38, v40
    v_mov_b32 v39, v41
    s_nop 1
    v_permlane32_swap_b32 v40, v38
    v_permlane32_swap_b32 v41, v39
    s_nop 1
    v_add_f32 v40, v40, v38
    v_add_f32 v41, v41, v39
    v_mul_f32 v40, s88, v40
    v_mul_f32 v41, s88, v41
    v_cvt_pk_bf16_f32 v42, v36, v37
    v_lshlrev_b32 v36, 16, v42
    v_and_b32 v37, 0xffff0000, v42
    v_cvt_pk_bf16_f32 v42, v40, v41
    v_lshlrev_b32 v40, 16, v42
    v_and_b32 v41, 0xffff0000, v42
    s_mov_b32 s88, 0x3727c5ac
    v_add_f32 v40, s88, v40
    v_add_f32 v41, s88, v41
    v_cvt_pk_bf16_f32 v42, v40, v41
    v_lshlrev_b32 v40, 16, v42
    v_and_b32 v41, 0xffff0000, v42
    v_sqrt_f32 v40, v40
    v_sqrt_f32 v41, v41
    s_nop 0
    v_cvt_pk_bf16_f32 v42, v40, v41
    v_lshlrev_b32 v40, 16, v42
    v_and_b32 v41, 0xffff0000, v42
    v_rcp_f32 v44, v40
    v_rcp_f32 v45, v41
    v_sub_f32 v20, v20, v36
    v_sub_f32 v28, v28, v37
    v_cvt_pk_bf16_f32 v42, v20, v28
    v_lshlrev_b32 v20, 16, v42
    v_and_b32 v28, 0xffff0000, v42
    v_mul_f32 v48, v20, v44
    v_fma_f32 v43, -v48, v40, v20
    v_fmac_f32 v48, v43, v44
    v_mul_f32 v49, v28, v45
    v_fma_f32 v43, -v49, v41, v28
    v_fmac_f32 v49, v43, v45
    v_cvt_pk_bf16_f32 v42, v48, v49
    v_lshlrev_b32 v48, 16, v42
    v_and_b32 v49, 0xffff0000, v42
    v_sub_f32 v21, v21, v36
    v_sub_f32 v29, v29, v37
    v_cvt_pk_bf16_f32 v42, v21, v29
    v_lshlrev_b32 v21, 16, v42
    v_and_b32 v29, 0xffff0000, v42
    v_mul_f32 v50, v21, v44
    v_fma_f32 v43, -v50, v40, v21
    v_fmac_f32 v50, v43, v44
    v_mul_f32 v51, v29, v45
    v_fma_f32 v43, -v51, v41, v29
    v_fmac_f32 v51, v43, v45
    v_cvt_pk_bf16_f32 v42, v50, v51
    v_lshlrev_b32 v50, 16, v42
    v_and_b32 v51, 0xffff0000, v42
    v_sub_f32 v22, v22, v36
    v_sub_f32 v30, v30, v37
    v_cvt_pk_bf16_f32 v42, v22, v30
    v_lshlrev_b32 v22, 16, v42
    v_and_b32 v30, 0xffff0000, v42
    v_mul_f32 v52, v22, v44
    v_fma_f32 v43, -v52, v40, v22
    v_fmac_f32 v52, v43, v44
    v_mul_f32 v53, v30, v45
    v_fma_f32 v43, -v53, v41, v30
    v_fmac_f32 v53, v43, v45
    v_cvt_pk_bf16_f32 v42, v52, v53
    v_lshlrev_b32 v52, 16, v42
    v_and_b32 v53, 0xffff0000, v42
    v_sub_f32 v23, v23, v36
    v_sub_f32 v31, v31, v37
    v_cvt_pk_bf16_f32 v42, v23, v31
    v_lshlrev_b32 v23, 16, v42
    v_and_b32 v31, 0xffff0000, v42
    v_mul_f32 v54, v23, v44
    v_fma_f32 v43, -v54, v40, v23
    v_fmac_f32 v54, v43, v44
    v_mul_f32 v55, v31, v45
    v_fma_f32 v43, -v55, v41, v31
    v_fmac_f32 v55, v43, v45
    v_cvt_pk_bf16_f32 v42, v54, v55
    v_lshlrev_b32 v54, 16, v42
    v_and_b32 v55, 0xffff0000, v42
    v_sub_f32 v24, v24, v36
    v_sub_f32 v32, v32, v37
    v_cvt_pk_bf16_f32 v42, v24, v32
    v_lshlrev_b32 v24, 16, v42
    v_and_b32 v32, 0xffff0000, v42
    v_mul_f32 v56, v24, v44
    v_fma_f32 v43, -v56, v40, v24
    v_fmac_f32 v56, v43, v44
    v_mul_f32 v57, v32, v45
    v_fma_f32 v43, -v57, v41, v32
    v_fmac_f32 v57, v43, v45
    v_cvt_pk_bf16_f32 v42, v56, v57
    v_lshlrev_b32 v56, 16, v42
    v_and_b32 v57, 0xffff0000, v42
    v_sub_f32 v25, v25, v36
    v_sub_f32 v33, v33, v37
    v_cvt_pk_bf16_f32 v42, v25, v33
    v_lshlrev_b32 v25, 16, v42
    v_and_b32 v33, 0xffff0000, v42
    v_mul_f32 v58, v25, v44
    v_fma_f32 v43, -v58, v40, v25
    v_fmac_f32 v58, v43, v44
    v_mul_f32 v59, v33, v45
    v_fma_f32 v43, -v59, v41, v33
    v_fmac_f32 v59, v43, v45
    v_cvt_pk_bf16_f32 v42, v58, v59
    v_lshlrev_b32 v58, 16, v42
    v_and_b32 v59, 0xffff0000, v42
    v_sub_f32 v26, v26, v36
    v_sub_f32 v34, v34, v37
    v_cvt_pk_bf16_f32 v42, v26, v34
    v_lshlrev_b32 v26, 16, v42
    v_and_b32 v34, 0xffff0000, v42
    v_mul_f32 v60, v26, v44
    v_fma_f32 v43, -v60, v40, v26
    v_fmac_f32 v60, v43, v44
    v_mul_f32 v61, v34, v45
    v_fma_f32 v43, -v61, v41, v34
    v_fmac_f32 v61, v43, v45
    v_cvt_pk_bf16_f32 v42, v60, v61
    v_lshlrev_b32 v60, 16, v42
    v_and_b32 v61, 0xffff0000, v42
    v_sub_f32 v27, v27, v36
    v_sub_f32 v35, v35, v37
    v_cvt_pk_bf16_f32 v42, v27, v35
    v_lshlrev_b32 v27, 16, v42
    v_and_b32 v35, 0xffff0000, v42
    v_mul_f32 v62, v27, v44
    v_fma_f32 v43, -v62, v40, v27
    v_fmac_f32 v62, v43, v44
    v_mul_f32 v63, v35, v45
    v_fma_f32 v43, -v63, v41, v35
    v_fmac_f32 v63, v43, v45
    v_cvt_pk_bf16_f32 v42, v62, v63
    v_lshlrev_b32 v62, 16, v42
    v_and_b32 v63, 0xffff0000, v42
    v_lshlrev_b32 v1, 6, v0
    v_add_u32 v1, 131072, v1
    ds_write_b128 v1, v[48:51] offset:0
    ds_write_b128 v1, v[52:55] offset:16
    ds_write_b128 v1, v[56:59] offset:32
    ds_write_b128 v1, v[60:63] offset:48
    s_cmp_ge_u32 s3, 2
    s_cbranch_scc0 L_aux_early
    v_mov_b32 v17, 153088
    s_mov_b32 s93, 0
L_rn_ffn:
    ds_read_b32 v16, v17
    s_waitcnt lgkmcnt(0)
    v_readfirstlane_b32 s92, v16
    s_add_u32 s93, s93, 1
    s_cmp_lg_u32 s92, 0
    s_cbranch_scc1 L_rn_ffn_ok
    s_cmp_lt_u32 s93, 3200000
    s_cbranch_scc1 L_rn_ffn
L_rn_ffn_ok:
    s_bfe_u32 s16, s92, 524288
    s_bfe_u32 s17, s92, 524296
    s_bfe_u32 s18, s92, 524304
    s_bfe_u32 s19, s92, 524312
    v_mov_b32 v17, 153124
    s_mov_b32 s90, 0
L_iw:
    ds_read_b32 v16, v17
    s_waitcnt lgkmcnt(0)
    v_readfirstlane_b32 s88, v16
    s_add_u32 s90, s90, 1
    s_cmp_eq_u32 s88, s92
    s_cbranch_scc1 L_iw_ok
    s_sleep 4
    s_cmp_lt_u32 s90, 3200000
    s_cbranch_scc1 L_iw
L_iw_ok:
    buffer_load_dwordx4 v[64:67], v12, s[84:87], s7 offen nt
    s_add_u32 s7, s7, s8
    buffer_load_dwordx4 v[68:71], v12, s[84:87], s7 offen nt
    s_add_u32 s7, s7, s8
    buffer_load_dwordx4 v[72:75], v12, s[84:87], s7 offen nt
    s_add_u32 s7, s7, s8
    buffer_load_dwordx4 v[76:79], v12, s[84:87], s7 offen nt
    s_add_u32 s7, s7, s8
    buffer_load_dwordx4 v[80:83], v12, s[84:87], s7 offen nt
    s_add_u32 s7, s7, s8
    buffer_load_dwordx4 v[84:87], v12, s[84:87], s7 offen nt
    s_add_u32 s7, s7, s8
    buffer_load_dwordx4 v[88:91], v12, s[84:87], s7 offen nt
    s_add_u32 s7, s7, s8
    buffer_load_dwordx4 v[92:95], v12, s[84:87], s7 offen nt
L_aux_early:
    s_waitcnt lgkmcnt(0)
    s_lshl_b32 s9, s5, 3
    s_add_u32 s9, s9, 131072
    v_lshlrev_b32 v13, 3, v10
    v_add_u32 v13, s9, v13
    ds_read_b64 v[20:21], v13 offset:0
    ds_read_b64 v[22:23], v13 offset:64
    ds_read_b64 v[24:25], v13 offset:128
    ds_read_b64 v[26:27], v13 offset:192
    ds_read_b64 v[28:29], v13 offset:256
    ds_read_b64 v[30:31], v13 offset:320
    ds_read_b64 v[32:33], v13 offset:384
    ds_read_b64 v[34:35], v13 offset:448
    s_waitcnt lgkmcnt(0)
    s_waitcnt vmcnt(7)
    v_lshlrev_b32 v52, 16, v64
    v_and_b32 v53, 0xffff0000, v64
    v_mul_f32 v36, v52, v20
    v_mul_f32 v37, v53, v20
    v_mul_f32 v44, v52, v21
    v_mul_f32 v45, v53, v21
    v_lshlrev_b32 v52, 16, v65
    v_and_b32 v53, 0xffff0000, v65
    v_mul_f32 v38, v52, v20
    v_mul_f32 v39, v53, v20
    v_mul_f32 v46, v52, v21
    v_mul_f32 v47, v53, v21
    v_lshlrev_b32 v52, 16, v66
    v_and_b32 v53, 0xffff0000, v66
    v_mul_f32 v40, v52, v20
    v_mul_f32 v41, v53, v20
    v_mul_f32 v48, v52, v21
    v_mul_f32 v49, v53, v21
    v_lshlrev_b32 v52, 16, v67
    v_and_b32 v53, 0xffff0000, v67
    v_mul_f32 v42, v52, v20
    v_mul_f32 v43, v53, v20
    v_mul_f32 v50, v52, v21
    v_mul_f32 v51, v53, v21
    s_waitcnt vmcnt(6)
    v_lshlrev_b32 v52, 16, v68
    v_and_b32 v53, 0xffff0000, v68
    v_fmac_f32 v36, v52, v22
    v_fmac_f32 v37, v53, v22
    v_fmac_f32 v44, v52, v23
    v_fmac_f32 v45, v53, v23
    v_lshlrev_b32 v52, 16, v69
    v_and_b32 v53, 0xffff0000, v69
    v_fmac_f32 v38, v52, v22
    v_fmac_f32 v39, v53, v22
    v_fmac_f32 v46, v52, v23
    v_fmac_f32 v47, v53, v23
    v_lshlrev_b32 v52, 16, v70
    v_and_b32 v53, 0xffff0000, v70
    v_fmac_f32 v40, v52, v22
    v_fmac_f32 v41, v53, v22
    v_fmac_f32 v48, v52, v23
    v_fmac_f32 v49, v53, v23
    v_lshlrev_b32 v52, 16, v71
    v_and_b32 v53, 0xffff0000, v71
    v_fmac_f32 v42, v52, v22
    v_fmac_f32 v43, v53, v22
    v_fmac_f32 v50, v52, v23
    v_fmac_f32 v51, v53, v23
    s_waitcnt vmcnt(5)
    v_lshlrev_b32 v52, 16, v72
    v_and_b32 v53, 0xffff0000, v72
    v_fmac_f32 v36, v52, v24
    v_fmac_f32 v37, v53, v24
    v_fmac_f32 v44, v52, v25
    v_fmac_f32 v45, v53, v25
    v_lshlrev_b32 v52, 16, v73
    v_and_b32 v53, 0xffff0000, v73
    v_fmac_f32 v38, v52, v24
    v_fmac_f32 v39, v53, v24
    v_fmac_f32 v46, v52, v25
    v_fmac_f32 v47, v53, v25
    v_lshlrev_b32 v52, 16, v74
    v_and_b32 v53, 0xffff0000, v74
    v_fmac_f32 v40, v52, v24
    v_fmac_f32 v41, v53, v24
    v_fmac_f32 v48, v52, v25
    v_fmac_f32 v49, v53, v25
    v_lshlrev_b32 v52, 16, v75
    v_and_b32 v53, 0xffff0000, v75
    v_fmac_f32 v42, v52, v24
    v_fmac_f32 v43, v53, v24
    v_fmac_f32 v50, v52, v25
    v_fmac_f32 v51, v53, v25
    s_waitcnt vmcnt(4)
    v_lshlrev_b32 v52, 16, v76
    v_and_b32 v53, 0xffff0000, v76
    v_fmac_f32 v36, v52, v26
    v_fmac_f32 v37, v53, v26
    v_fmac_f32 v44, v52, v27
    v_fmac_f32 v45, v53, v27
    v_lshlrev_b32 v52, 16, v77
    v_and_b32 v53, 0xffff0000, v77
    v_fmac_f32 v38, v52, v26
    v_fmac_f32 v39, v53, v26
    v_fmac_f32 v46, v52, v27
    v_fmac_f32 v47, v53, v27
    v_lshlrev_b32 v52, 16, v78
    v_and_b32 v53, 0xffff0000, v78
    v_fmac_f32 v40, v52, v26
    v_fmac_f32 v41, v53, v26
    v_fmac_f32 v48, v52, v27
    v_fmac_f32 v49, v53, v27
    v_lshlrev_b32 v52, 16, v79
    v_and_b32 v53, 0xffff0000, v79
    v_fmac_f32 v42, v52, v26
    v_fmac_f32 v43, v53, v26
    v_fmac_f32 v50, v52, v27
    v_fmac_f32 v51, v53, v27
    s_waitcnt vmcnt(3)
    v_lshlrev_b32 v52, 16, v80
    v_and_b32 v53, 0xffff0000, v80
    v_fmac_f32 v36, v52, v28
    v_fmac_f32 v37, v53, v28
    v_fmac_f32 v44, v52, v29
    v_fmac_f32 v45, v53, v29
    v_lshlrev_b32 v52, 16, v81
    v_and_b32 v53, 0xffff0000, v81
    v_fmac_f32 v38, v52, v28
    v_fmac_f32 v39, v53, v28
    v_fmac_f32 v46, v52, v29
    v_fmac_f32 v47, v53, v29
    v_lshlrev_b32 v52, 16, v82
    v_and_b32 v53, 0xffff0000, v82
    v_fmac_f32 v40, v52, v28
    v_fmac_f32 v41, v53, v28
    v_fmac_f32 v48, v52, v29
    v_fmac_f32 v49, v53, v29
    v_lshlrev_b32 v52, 16, v83
    v_and_b32 v53, 0xffff0000, v83
    v_fmac_f32 v42, v52, v28
    v_fmac_f32 v43, v53, v28
    v_fmac_f32 v50, v52, v29
    v_fmac_f32 v51, v53, v29
    s_waitcnt vmcnt(2)
    v_lshlrev_b32 v52, 16, v84
    v_and_b32 v53, 0xffff0000, v84
    v_fmac_f32 v36, v52, v30
    v_fmac_f32 v37, v53, v30
    v_fmac_f32 v44, v52, v31
    v_fmac_f32 v45, v53, v31
    v_lshlrev_b32 v52, 16, v85
    v_and_b32 v53, 0xffff0000, v85
    v_fmac_f32 v38, v52, v30
    v_fmac_f32 v39, v53, v30
    v_fmac_f32 v46, v52, v31
    v_fmac_f32 v47, v53, v31
    v_lshlrev_b32 v52, 16, v86
    v_and_b32 v53, 0xffff0000, v86
    v_fmac_f32 v40, v52, v30
    v_fmac_f32 v41, v53, v30
    v_fmac_f32 v48, v52, v31
    v_fmac_f32 v49, v53, v31
    v_lshlrev_b32 v52, 16, v87
    v_and_b32 v53, 0xffff0000, v87
    v_fmac_f32 v42, v52, v30
    v_fmac_f32 v43, v53, v30
    v_fmac_f32 v50, v52, v31
    v_fmac_f32 v51, v53, v31
    s_waitcnt vmcnt(1)
    v_lshlrev_b32 v52, 16, v88
    v_and_b32 v53, 0xffff0000, v88
    v_fmac_f32 v36, v52, v32
    v_fmac_f32 v37, v53, v32
    v_fmac_f32 v44, v52, v33
    v_fmac_f32 v45, v53, v33
    v_lshlrev_b32 v52, 16, v89
    v_and_b32 v53, 0xffff0000, v89
    v_fmac_f32 v38, v52, v32
    v_fmac_f32 v39, v53, v32
    v_fmac_f32 v46, v52, v33
    v_fmac_f32 v47, v53, v33
    v_lshlrev_b32 v52, 16, v90
    v_and_b32 v53, 0xffff0000, v90
    v_fmac_f32 v40, v52, v32
    v_fmac_f32 v41, v53, v32
    v_fmac_f32 v48, v52, v33
    v_fmac_f32 v49, v53, v33
    v_lshlrev_b32 v52, 16, v91
    v_and_b32 v53, 0xffff0000, v91
    v_fmac_f32 v42, v52, v32
    v_fmac_f32 v43, v53, v32
    v_fmac_f32 v50, v52, v33
    v_fmac_f32 v51, v53, v33
    s_waitcnt vmcnt(0)
    v_lshlrev_b32 v52, 16, v92
    v_and_b32 v53, 0xffff0000, v92
    v_fmac_f32 v36, v52, v34
    v_fmac_f32 v37, v53, v34
    v_fmac_f32 v44, v52, v35
    v_fmac_f32 v45, v53, v35
    v_lshlrev_b32 v52, 16, v93
    v_and_b32 v53, 0xffff0000, v93
    v_fmac_f32 v38, v52, v34
    v_fmac_f32 v39, v53, v34
    v_fmac_f32 v46, v52, v35
    v_fmac_f32 v47, v53, v35
    v_lshlrev_b32 v52, 16, v94
    v_and_b32 v53, 0xffff0000, v94
    v_fmac_f32 v40, v52, v34
    v_fmac_f32 v41, v53, v34
    v_fmac_f32 v48, v52, v35
    v_fmac_f32 v49, v53, v35
    v_lshlrev_b32 v52, 16, v95
    v_and_b32 v53, 0xffff0000, v95
    v_fmac_f32 v42, v52, v34
    v_fmac_f32 v43, v53, v34
    v_fmac_f32 v50, v52, v35
    v_fmac_f32 v51, v53, v35
    v_lshlrev_b32 v1, 9, v10
    v_lshl_add_u32 v1, v11, 5, v1
    v_add_u32 v1, s11, v1
    ds_write_b128 v1, v[36:39]
    ds_write_b128 v1, v[40:43] offset:16
    ds_write_b128 v1, v[44:47] offset:256
    ds_write_b128 v1, v[48:51] offset:272
    s_waitcnt lgkmcnt(0)
    v_and_b32 v2, 31, v0
    v_lshrrev_b32 v3, 5, v0
    v_lshlrev_b32 v1, 4, v2
    v_lshl_add_u32 v1, v3, 11, v1
    v_add_u32 v1, s11, v1
    ds_read_b128 v[64:67], v1 offset:0
    ds_read_b128 v[68:71], v1 offset:512
    ds_read_b128 v[72:75], v1 offset:1024
    ds_read_b128 v[76:79], v1 offset:1536
    s_waitcnt lgkmcnt(0)
    v_add_f32 v64, v64, v68
    v_add_f32 v72, v72, v76
    v_add_f32 v64, v64, v72
    v_add_f32 v65, v65, v69
    v_add_f32 v73, v73, v77
    v_add_f32 v65, v65, v73
    v_add_f32 v66, v66, v70
    v_add_f32 v74, v74, v78
    v_add_f32 v66, v66, v74
    v_add_f32 v67, v67, v71
    v_add_f32 v75, v75, v79
    v_add_f32 v67, v67, v75
    v_mov_b32 v68, v64
    v_mov_b32 v69, v65
    v_mov_b32 v70, v66
    v_mov_b32 v71, v67
    s_nop 1
    v_permlane32_swap_b32 v64, v68
    v_permlane32_swap_b32 v65, v69
    v_permlane32_swap_b32 v66, v70
    v_permlane32_swap_b32 v67, v71
    s_nop 1
    v_add_f32 v64, v64, v68
    v_add_f32 v65, v65, v69
    v_add_f32 v66, v66, v70
    v_add_f32 v67, v67, v71
    v_mov_b32 v17, 153088
    s_mov_b32 s93, 0
L_rn_aux:
    ds_read_b32 v16, v17
    s_waitcnt lgkmcnt(0)
    v_readfirstlane_b32 s92, v16
    s_add_u32 s93, s93, 1
    s_cmp_lg_u32 s92, 0
    s_cbranch_scc1 L_rn_aux_ok
    s_cmp_lt_u32 s93, 3200000
    s_cbranch_scc1 L_rn_aux
L_rn_aux_ok:
    s_bfe_u32 s16, s92, 524288
    s_bfe_u32 s17, s92, 524296
    s_bfe_u32 s18, s92, 524304
    s_bfe_u32 s19, s92, 524312
    v_lshrrev_b32 v3, 4, v2
    v_mul_lo_u32 v3, v3, s12
    v_and_b32 v4, 15, v2
    s_cmp_ge_u32 s3, 2
    s_cbranch_scc1 L_aux_st_gu
    v_lshlrev_b32 v5, 4, v2
    v_add_u32 v5, 153152, v5
    v_mov_b32 v6, 153120
    v_mov_b32 v7, s92
    s_cmp_eq_u32 s3, 0
    s_cbranch_scc1 L_aux_st_q0
    ds_write_b128 v5, v[64:67]
    s_waitcnt lgkmcnt(0)
    ds_write_b32 v6, v7
    s_branch L_aux_st_skip
L_aux_st_q0:
    s_mov_b32 s90, 0
L_px:
    ds_read_b32 v8, v6
    s_waitcnt lgkmcnt(0)
    v_readfirstlane_b32 s88, v8
    s_add_u32 s90, s90, 1
    s_cmp_eq_u32 s88, s92
    s_cbranch_scc1 L_px_ok
    s_cmp_lt_u32 s90, 3200000
    s_cbranch_scc1 L_px
L_px_ok:
    ds_read_b128 v[68:71], v5
    s_waitcnt lgkmcnt(0)
    v_add_f32 v64, v64, v68
    v_add_f32 v65, v65, v69
    v_add_f32 v68, v66, v70
    v_add_f32 v69, v67, v71
    v_mov_b32 v66, s92
    v_mov_b32 v67, s92
    v_mov_b32 v70, s92
    v_mov_b32 v71, s92
    v_lshl_add_u32 v3, v4, 5, v3
    s_mov_b32 exec_hi, 0
    buffer_store_dwordx4 v[64:67], v3, s[80:83], s13 offen sc1
    buffer_store_dwordx4 v[68:71], v3, s[80:83], s13 offen offset:16 sc1
    s_mov_b64 exec, -1
    s_branch L_aux_st_skip
L_aux_st_gu:
    v_add_u32 v64, 0x80, v64
    v_bfi_b32 v64, v15, s16, v64
    v_add_u32 v65, 0x80, v65
    v_bfi_b32 v65, v15, s17, v65
    v_add_u32 v66, 0x80, v66
    v_bfi_b32 v66, v15, s18, v66
    v_add_u32 v67, 0x80, v67
    v_bfi_b32 v67, v15, s19, v67
    v_lshl_add_u32 v3, v4, 4, v3
    s_cmp_ge_u32 s2, 224
    s_cbranch_scc1 L_aux_st_skip
    s_mov_b32 exec_hi, 0
    buffer_store_dwordx4 v[64:67], v3, s[80:83], s13 offen sc1
    s_mov_b64 exec, -1
L_aux_st_skip:
    s_lshr_b32 s4, s2, 5
    s_bfe_u32 s5, s2, 0x10004
    s_and_b32 s6, s2, 31
    s_mov_b32 s14, 0
    v_lshlrev_b32 v12, 10, v10
    v_lshl_add_u32 v12, v11, 4, v12
    s_lshl_b32 s89, s4, 7
    s_cmp_ge_u32 s3, 2
    s_cbranch_scc1 L_aux_ffn
    v_bfe_u32 v1, v0, 2, 2
    v_lshlrev_b32 v1, 16, v1
    v_and_b32 v2, 3, v0
    v_lshl_add_u32 v1, v2, 9, v1
    s_lshl_b32 s88, s5, 15
    s_lshl_b32 s89, s4, 12
    s_add_u32 s88, s88, s89
    s_lshl_b32 s89, s3, 11
    s_add_u32 s88, s88, s89
    s_add_u32 s90, s88, 0
L_qs:
    buffer_load_dwordx4 v[4:7], v1, s[80:83], s90 offen offset:496 sc1
    s_waitcnt vmcnt(0)
    v_xor_b32 v4, s92, v6
    v_xor_b32 v5, s92, v7
    v_or_b32 v4, v4, v5
    v_cmp_ne_u32 vcc, 0, v4
    s_nop 4
    s_cbranch_vccz L_qs_ok
    s_sleep 1
    s_add_u32 s14, s14, 1
    s_cmp_lt_u32 s14, 400000
    s_cbranch_scc1 L_qs
L_qs_ok:
    v_lshlrev_b32 v2, 5, v0
L_qg:
    s_mov_b32 s88, s90
    buffer_load_dwordx4 v[64:67], v2, s[80:83], s88 offen sc1
    buffer_load_dwordx4 v[68:71], v2, s[80:83], s88 offen offset:16 sc1
    s_add_u32 s88, s88, 65536
    buffer_load_dwordx4 v[72:75], v2, s[80:83], s88 offen sc1
    buffer_load_dwordx4 v[76:79], v2, s[80:83], s88 offen offset:16 sc1
    s_add_u32 s88, s88, 65536
    buffer_load_dwordx4 v[80:83], v2, s[80:83], s88 offen sc1
    buffer_load_dwordx4 v[84:87], v2, s[80:83], s88 offen offset:16 sc1
    s_add_u32 s88, s88, 65536
    buffer_load_dwordx4 v[88:91], v2, s[80:83], s88 offen sc1
    buffer_load_dwordx4 v[92:95], v2, s[80:83], s88 offen offset:16 sc1
    s_waitcnt vmcnt(0)
    v_xor_b32 v5, s92, v66
    v_xor_b32 v6, s92, v67
    v_or_b32 v4, v5, v6
    v_xor_b32 v5, s92, v70
    v_xor_b32 v6, s92, v71
    v_or3_b32 v4, v4, v5, v6
    v_xor_b32 v5, s92, v74
    v_xor_b32 v6, s92, v75
    v_or3_b32 v4, v4, v5, v6
    v_xor_b32 v5, s92, v78
    v_xor_b32 v6, s92, v79
    v_or3_b32 v4, v4, v5, v6
    v_xor_b32 v5, s92, v82
    v_xor_b32 v6, s92, v83
    v_or3_b32 v4, v4, v5, v6
    v_xor_b32 v5, s92, v86
    v_xor_b32 v6, s92, v87
    v_or3_b32 v4, v4, v5, v6
    v_xor_b32 v5, s92, v90
    v_xor_b32 v6, s92, v91
    v_or3_b32 v4, v4, v5, v6
    v_xor_b32 v5, s92, v94
    v_xor_b32 v6, s92, v95
    v_or3_b32 v4, v4, v5, v6
    v_cmp_ne_u32 vcc, 0, v4
    s_nop 4
    s_cbranch_vccz L_qg_ok
    s_sleep 1
    s_add_u32 s14, s14, 1
    s_cmp_lt_u32 s14, 400000
    s_cbranch_scc1 L_qg
L_qg_ok:
    v_add_f32 v64, v64, v72
    v_add_f32 v80, v80, v88
    v_add_f32 v64, v64, v80
    v_add_f32 v65, v65, v73
    v_add_f32 v81, v81, v89
    v_add_f32 v65, v65, v81
    v_add_f32 v68, v68, v76
    v_add_f32 v84, v84, v92
    v_add_f32 v68, v68, v84
    v_add_f32 v69, v69, v77
    v_add_f32 v85, v85, v93
    v_add_f32 v69, v69, v85
    v_cvt_pk_bf16_f32 v4, v64, v65
    v_cvt_pk_bf16_f32 v5, v68, v69
    s_lshl_b32 s88, s3, 9
    s_add_u32 s88, s88, 151552
    v_lshlrev_b32 v3, 3, v0
    v_add_u32 v3, s88, v3
    ds_write_b64 v3, v[4:5]
    s_lshl_b32 s88, s3, 2
    s_add_u32 s88, s88, 153128
    v_mov_b32 v6, s88
    v_mov_b32 v7, s92
    s_waitcnt lgkmcnt(0)
    ds_write_b32 v6, v7
    s_cmp_lg_u32 s3, 0
    s_cbranch_scc1 L_end
    s_lshl_b32 s89, s4, 7
    s_lshl_b32 s88, s6, 17
    s_add_u32 s88, s88, s89
    buffer_load_dwordx4 v[128:131], v12, s[56:59], s88 offen nt
    s_add_u32 s88, s88, 8192
    buffer_load_dwordx4 v[132:135], v12, s[56:59], s88 offen nt
    s_add_u32 s88, s88, 8192
    buffer_load_dwordx4 v[136:139], v12, s[56:59], s88 offen nt
    s_add_u32 s88, s88, 8192
    buffer_load_dwordx4 v[140:143], v12, s[56:59], s88 offen nt
    s_add_u32 s88, s88, 8192
    buffer_load_dwordx4 v[144:147], v12, s[56:59], s88 offen nt
    s_add_u32 s88, s88, 8192
    buffer_load_dwordx4 v[148:151], v12, s[56:59], s88 offen nt
    s_add_u32 s88, s88, 8192
    buffer_load_dwordx4 v[152:155], v12, s[56:59], s88 offen nt
    s_add_u32 s88, s88, 8192
    buffer_load_dwordx4 v[156:159], v12, s[56:59], s88 offen nt
    s_add_u32 s88, s88, 8192
    buffer_load_dwordx4 v[160:163], v12, s[56:59], s88 offen nt
    s_add_u32 s88, s88, 8192
    buffer_load_dwordx4 v[164:167], v12, s[56:59], s88 offen nt
    s_add_u32 s88, s88, 8192
    buffer_load_dwordx4 v[168:171], v12, s[56:59], s88 offen nt
    s_add_u32 s88, s88, 8192
    buffer_load_dwordx4 v[172:175], v12, s[56:59], s88 offen nt
    s_add_u32 s88, s88, 8192
    buffer_load_dwordx4 v[176:179], v12, s[56:59], s88 offen nt
    s_add_u32 s88, s88, 8192
    buffer_load_dwordx4 v[180:183], v12, s[56:59], s88 offen nt
    s_add_u32 s88, s88, 8192
    buffer_load_dwordx4 v[184:187], v12, s[56:59], s88 offen nt
    s_add_u32 s88, s88, 8192
    buffer_load_dwordx4 v[188:191], v12, s[56:59], s88 offen nt
    s_waitcnt vmcnt(0)
    s_movk_i32 s88, 144
    v_mul_lo_u32 v1, v10, s88
    v_lshl_add_u32 v1, v11, 4, v1
    v_add_u32 v1, 135168, v1
    v_lshrrev_b32 v2, 4, v0
    v_bfe_u32 v3, v0, 2, 2
    v_lshl_add_u32 v2, v2, 3, v3
    v_and_b32 v3, 3, v0
    v_mul_lo_u32 v2, v2, s88
    v_lshl_add_u32 v2, v3, 3, v2
    v_add_u32 v2, 135168, v2
    ds_write_b128 v1, v[128:131] offset:0
    ds_write_b128 v1, v[132:135] offset:1152
    ds_write_b128 v1, v[136:139] offset:2304
    ds_write_b128 v1, v[140:143] offset:3456
    s_waitcnt lgkmcnt(0)
    ds_read_b64_tr_b16 v[64:65], v2 offset:0
    ds_read_b64_tr_b16 v[66:67], v2 offset:576
    ds_read_b64_tr_b16 v[68:69], v2 offset:32
    ds_read_b64_tr_b16 v[70:71], v2 offset:608
    ds_read_b64_tr_b16 v[72:73], v2 offset:64
    ds_read_b64_tr_b16 v[74:75], v2 offset:640
    ds_read_b64_tr_b16 v[76:77], v2 offset:96
    ds_read_b64_tr_b16 v[78:79], v2 offset:672
    s_waitcnt lgkmcnt(0)
    ds_write_b128 v1, v[144:147] offset:0
    ds_write_b128 v1, v[148:151] offset:1152
    ds_write_b128 v1, v[152:155] offset:2304
    ds_write_b128 v1, v[156:159] offset:3456
    s_waitcnt lgkmcnt(0)
    ds_read_b64_tr_b16 v[80:81], v2 offset:0
    ds_read_b64_tr_b16 v[82:83], v2 offset:576
    ds_read_b64_tr_b16 v[84:85], v2 offset:32
    ds_read_b64_tr_b16 v[86:87], v2 offset:608
    ds_read_b64_tr_b16 v[88:89], v2 offset:64
    ds_read_b64_tr_b16 v[90:91], v2 offset:640
    ds_read_b64_tr_b16 v[92:93], v2 offset:96
    ds_read_b64_tr_b16 v[94:95], v2 offset:672
    s_waitcnt lgkmcnt(0)
    ds_write_b128 v1, v[160:163] offset:0
    ds_write_b128 v1, v[164:167] offset:1152
    ds_write_b128 v1, v[168:171] offset:2304
    ds_write_b128 v1, v[172:175] offset:3456
    s_waitcnt lgkmcnt(0)
    ds_read_b64_tr_b16 v[96:97], v2 offset:0
    ds_read_b64_tr_b16 v[98:99], v2 offset:576
    ds_read_b64_tr_b16 v[100:101], v2 offset:32
    ds_read_b64_tr_b16 v[102:103], v2 offset:608
    ds_read_b64_tr_b16 v[104:105], v2 offset:64
    ds_read_b64_tr_b16 v[106:107], v2 offset:640
    ds_read_b64_tr_b16 v[108:109], v2 offset:96
    ds_read_b64_tr_b16 v[110:111], v2 offset:672
    s_waitcnt lgkmcnt(0)
    ds_write_b128 v1, v[176:179] offset:0
    ds_write_b128 v1, v[180:183] offset:1152
    ds_write_b128 v1, v[184:187] offset:2304
    ds_write_b128 v1, v[188:191] offset:3456
    s_waitcnt lgkmcnt(0)
    ds_read_b64_tr_b16 v[112:113], v2 offset:0
    ds_read_b64_tr_b16 v[114:115], v2 offset:576
    ds_read_b64_tr_b16 v[116:117], v2 offset:32
    ds_read_b64_tr_b16 v[118:119], v2 offset:608
    ds_read_b64_tr_b16 v[120:121], v2 offset:64
    ds_read_b64_tr_b16 v[122:123], v2 offset:640
    ds_read_b64_tr_b16 v[124:125], v2 offset:96
    ds_read_b64_tr_b16 v[126:127], v2 offset:672
    s_waitcnt lgkmcnt(0)
    s_lshr_b32 s7, s6, 2
    s_mov_b32 s14, 0
    s_lshl_b32 s88, s7, 7
    s_and_b32 s89, s6, 3
    s_add_u32 s88, s88, s89
    s_mul_i32 s88, s88, 528
    s_add_u32 s90, s88, 491520
    v_and_b32 v1, 15, v0
    s_mov_b32 s89, 2112
    v_mul_lo_u32 v2, v1, s89
    v_lshrrev_b32 v6, 5, v0
    v_and_b32 v7, 31, v0
    s_mov_b32 s89, 16896
    v_mul_lo_u32 v8, v6, s89
    v_lshl_add_u32 v8, v7, 4, v8
L_as:
    s_add_u32 s88, s90, 33792
    buffer_load_dwordx4 v[128:131], v2, s[80:83], s90 offen offset:512 sc1
    buffer_load_dwordx4 v[164:167], v2, s[80:83], s88 offen offset:512 sc1
    s_waitcnt vmcnt(0)
    v_xor_b32 v5, s16, v128
    v_xor_b32 v9, s17, v129
    v_or_b32 v4, v5, v9
    v_xor_b32 v5, s18, v130
    v_xor_b32 v9, s19, v131
    v_or3_b32 v4, v4, v5, v9
    v_xor_b32 v5, s16, v164
    v_xor_b32 v9, s17, v165
    v_or3_b32 v4, v4, v5, v9
    v_xor_b32 v5, s18, v166
    v_xor_b32 v9, s19, v167
    v_or3_b32 v4, v4, v5, v9
    v_and_b32 v4, 0xff, v4
    v_cmp_ne_u32 vcc, 0, v4
    s_nop 4
    s_cbranch_vccz L_as_ok
    s_sleep 1
    s_add_u32 s14, s14, 1
    s_cmp_lt_u32 s14, 400000
    s_cbranch_scc1 L_as
L_as_ok:
L_ag:
    s_mov_b32 s88, s90
    buffer_load_dwordx4 v[128:131], v2, s[80:83], s88 offen offset:512 sc1
    buffer_load_dwordx4 v[132:135], v8, s[80:83], s88 offen sc1
    s_add_u32 s88, s88, 2112
    buffer_load_dwordx4 v[136:139], v8, s[80:83], s88 offen sc1
    s_add_u32 s88, s88, 2112
    buffer_load_dwordx4 v[140:143], v8, s[80:83], s88 offen sc1
    s_add_u32 s88, s88, 2112
    buffer_load_dwordx4 v[144:147], v8, s[80:83], s88 offen sc1
    s_add_u32 s88, s88, 2112
    buffer_load_dwordx4 v[148:151], v8, s[80:83], s88 offen sc1
    s_add_u32 s88, s88, 2112
    buffer_load_dwordx4 v[152:155], v8, s[80:83], s88 offen sc1
    s_add_u32 s88, s88, 2112
    buffer_load_dwordx4 v[156:159], v8, s[80:83], s88 offen sc1
    s_add_u32 s88, s88, 2112
    buffer_load_dwordx4 v[160:163], v8, s[80:83], s88 offen sc1
    s_add_u32 s88, s88, 2112
    s_add_u32 s88, s88, 16896
    buffer_load_dwordx4 v[164:167], v2, s[80:83], s88 offen offset:512 sc1
    buffer_load_dwordx4 v[168:171], v8, s[80:83], s88 offen sc1
    s_add_u32 s88, s88, 2112
    buffer_load_dwordx4 v[172:175], v8, s[80:83], s88 offen sc1
    s_add_u32 s88, s88, 2112
    buffer_load_dwordx4 v[176:179], v8, s[80:83], s88 offen sc1
    s_add_u32 s88, s88, 2112
    buffer_load_dwordx4 v[180:183], v8, s[80:83], s88 offen sc1
    s_add_u32 s88, s88, 2112
    buffer_load_dwordx4 v[184:187], v8, s[80:83], s88 offen sc1
    s_add_u32 s88, s88, 2112
    buffer_load_dwordx4 v[188:191], v8, s[80:83], s88 offen sc1
    s_add_u32 s88, s88, 2112
    buffer_load_dwordx4 v[192:195], v8, s[80:83], s88 offen sc1
    s_add_u32 s88, s88, 2112
    buffer_load_dwordx4 v[196:199], v8, s[80:83], s88 offen sc1
    s_add_u32 s88, s88, 2112
    s_waitcnt vmcnt(0)
    v_xor_b32 v5, s16, v128
    v_xor_b32 v9, s17, v129
    v_or_b32 v4, v5, v9
    v_xor_b32 v5, s18, v130
    v_xor_b32 v9, s19, v131
    v_or3_b32 v4, v4, v5, v9
    v_xor_b32 v5, s16, v132
    v_xor_b32 v9, s17, v133
    v_or3_b32 v4, v4, v5, v9
    v_xor_b32 v5, s18, v134
    v_xor_b32 v9, s19, v135
    v_or3_b32 v4, v4, v5, v9
    v_xor_b32 v5, s16, v136
    v_xor_b32 v9, s17, v137
    v_or3_b32 v4, v4, v5, v9
    v_xor_b32 v5, s18, v138
    v_xor_b32 v9, s19, v139
    v_or3_b32 v4, v4, v5, v9
    v_xor_b32 v5, s16, v140
    v_xor_b32 v9, s17, v141
    v_or3_b32 v4, v4, v5, v9
    v_xor_b32 v5, s18, v142
    v_xor_b32 v9, s19, v143
    v_or3_b32 v4, v4, v5, v9
    v_xor_b32 v5, s16, v144
    v_xor_b32 v9, s17, v145
    v_or3_b32 v4, v4, v5, v9
    v_xor_b32 v5, s18, v146
    v_xor_b32 v9, s19, v147
    v_or3_b32 v4, v4, v5, v9
    v_xor_b32 v5, s16, v148
    v_xor_b32 v9, s17, v149
    v_or3_b32 v4, v4, v5, v9
    v_xor_b32 v5, s18, v150
    v_xor_b32 v9, s19, v151
    v_or3_b32 v4, v4, v5, v9
    v_xor_b32 v5, s16, v152
    v_xor_b32 v9, s17, v153
    v_or3_b32 v4, v4, v5, v9
    v_xor_b32 v5, s18, v154
    v_xor_b32 v9, s19, v155
    v_or3_b32 v4, v4, v5, v9
    v_xor_b32 v5, s16, v156
    v_xor_b32 v9, s17, v157
    v_or3_b32 v4, v4, v5, v9
    v_xor_b32 v5, s18, v158
    v_xor_b32 v9, s19, v159
    v_or3_b32 v4, v4, v5, v9
    v_xor_b32 v5, s16, v160
    v_xor_b32 v9, s17, v161
    v_or3_b32 v4, v4, v5, v9
    v_xor_b32 v5, s18, v162
    v_xor_b32 v9, s19, v163
    v_or3_b32 v4, v4, v5, v9
    v_xor_b32 v5, s16, v164
    v_xor_b32 v9, s17, v165
    v_or3_b32 v4, v4, v5, v9
    v_xor_b32 v5, s18, v166
    v_xor_b32 v9, s19, v167
    v_or3_b32 v4, v4, v5, v9
    v_xor_b32 v5, s16, v168
    v_xor_b32 v9, s17, v169
    v_or3_b32 v4, v4, v5, v9
    v_xor_b32 v5, s18, v170
    v_xor_b32 v9, s19, v171
    v_or3_b32 v4, v4, v5, v9
    v_xor_b32 v5, s16, v172
    v_xor_b32 v9, s17, v173
    v_or3_b32 v4, v4, v5, v9
    v_xor_b32 v5, s18, v174
    v_xor_b32 v9, s19, v175
    v_or3_b32 v4, v4, v5, v9
    v_xor_b32 v5, s16, v176
    v_xor_b32 v9, s17, v177
    v_or3_b32 v4, v4, v5, v9
    v_xor_b32 v5, s18, v178
    v_xor_b32 v9, s19, v179
    v_or3_b32 v4, v4, v5, v9
    v_xor_b32 v5, s16, v180
    v_xor_b32 v9, s17, v181
    v_or3_b32 v4, v4, v5, v9
    v_xor_b32 v5, s18, v182
    v_xor_b32 v9, s19, v183
    v_or3_b32 v4, v4, v5, v9
    v_xor_b32 v5, s16, v184
    v_xor_b32 v9, s17, v185
    v_or3_b32 v4, v4, v5, v9
    v_xor_b32 v5, s18, v186
    v_xor_b32 v9, s19, v187
    v_or3_b32 v4, v4, v5, v9
    v_xor_b32 v5, s16, v188
    v_xor_b32 v9, s17, v189
    v_or3_b32 v4, v4, v5, v9
    v_xor_b32 v5, s18, v190
    v_xor_b32 v9, s19, v191
    v_or3_b32 v4, v4, v5, v9
    v_xor_b32 v5, s16, v192
    v_xor_b32 v9, s17, v193
    v_or3_b32 v4, v4, v5, v9
    v_xor_b32 v5, s18, v194
    v_xor_b32 v9, s19, v195
    v_or3_b32 v4, v4, v5, v9
    v_xor_b32 v5, s16, v196
    v_xor_b32 v9, s17, v197
    v_or3_b32 v4, v4, v5, v9
    v_xor_b32 v5, s18, v198
    v_xor_b32 v9, s19, v199
    v_or3_b32 v4, v4, v5, v9
    v_and_b32 v4, 0xff, v4
    v_cmp_ne_u32 vcc, 0, v4
    s_nop 4
    s_cbranch_vccz L_ag_ok
    s_sleep 1
    s_add_u32 s14, s14, 1
    s_cmp_lt_u32 s14, 400000
    s_cbranch_scc1 L_ag
L_ag_ok:
    v_and_b32 v128, 0xffffff00, v128
    v_and_b32 v129, 0xffffff00, v129
    v_and_b32 v130, 0xffffff00, v130
    v_and_b32 v131, 0xffffff00, v131
    v_and_b32 v132, 0xffffff00, v132
    v_and_b32 v133, 0xffffff00, v133
    v_and_b32 v134, 0xffffff00, v134
    v_and_b32 v135, 0xffffff00, v135
    v_and_b32 v136, 0xffffff00, v136
    v_and_b32 v137, 0xffffff00, v137
    v_and_b32 v138, 0xffffff00, v138
    v_and_b32 v139, 0xffffff00, v139
    v_and_b32 v140, 0xffffff00, v140
    v_and_b32 v141, 0xffffff00, v141
    v_and_b32 v142, 0xffffff00, v142
    v_and_b32 v143, 0xffffff00, v143
    v_and_b32 v144, 0xffffff00, v144
    v_and_b32 v145, 0xffffff00, v145
    v_and_b32 v146, 0xffffff00, v146
    v_and_b32 v147, 0xffffff00, v147
    v_and_b32 v148, 0xffffff00, v148
    v_and_b32 v149, 0xffffff00, v149
    v_and_b32 v150, 0xffffff00, v150
    v_and_b32 v151, 0xffffff00, v151
    v_and_b32 v152, 0xffffff00, v152
    v_and_b32 v153, 0xffffff00, v153
    v_and_b32 v154, 0xffffff00, v154
    v_and_b32 v155, 0xffffff00, v155
    v_and_b32 v156, 0xffffff00, v156
    v_and_b32 v157, 0xffffff00, v157
    v_and_b32 v158, 0xffffff00, v158
    v_and_b32 v159, 0xffffff00, v159
    v_and_b32 v160, 0xffffff00, v160
    v_and_b32 v161, 0xffffff00, v161
    v_and_b32 v162, 0xffffff00, v162
    v_and_b32 v163, 0xffffff00, v163
    v_and_b32 v164, 0xffffff00, v164
    v_and_b32 v165, 0xffffff00, v165
    v_and_b32 v166, 0xffffff00, v166
    v_and_b32 v167, 0xffffff00, v167
    v_and_b32 v168, 0xffffff00, v168
    v_and_b32 v169, 0xffffff00, v169
    v_and_b32 v170, 0xffffff00, v170
    v_and_b32 v171, 0xffffff00, v171
    v_and_b32 v172, 0xffffff00, v172
    v_and_b32 v173, 0xffffff00, v173
    v_and_b32 v174, 0xffffff00, v174
    v_and_b32 v175, 0xffffff00, v175
    v_and_b32 v176, 0xffffff00, v176
    v_and_b32 v177, 0xffffff00, v177
    v_and_b32 v178, 0xffffff00, v178
    v_and_b32 v179, 0xffffff00, v179
    v_and_b32 v180, 0xffffff00, v180
    v_and_b32 v181, 0xffffff00, v181
    v_and_b32 v182, 0xffffff00, v182
    v_and_b32 v183, 0xffffff00, v183
    v_and_b32 v184, 0xffffff00, v184
    v_and_b32 v185, 0xffffff00, v185
    v_and_b32 v186, 0xffffff00, v186
    v_and_b32 v187, 0xffffff00, v187
    v_and_b32 v188, 0xffffff00, v188
    v_and_b32 v189, 0xffffff00, v189
    v_and_b32 v190, 0xffffff00, v190
    v_and_b32 v191, 0xffffff00, v191
    v_and_b32 v192, 0xffffff00, v192
    v_and_b32 v193, 0xffffff00, v193
    v_and_b32 v194, 0xffffff00, v194
    v_and_b32 v195, 0xffffff00, v195
    v_and_b32 v196, 0xffffff00, v196
    v_and_b32 v197, 0xffffff00, v197
    v_and_b32 v198, 0xffffff00, v198
    v_and_b32 v199, 0xffffff00, v199
    v_mov_b32 v20, v128
    v_mov_b32 v21, v164
    s_nop 1
    v_max_f32_dpp v20, v20, v20 quad_perm:[1,0,3,2] row_mask:0xf bank_mask:0xf
    v_max_f32_dpp v21, v21, v21 quad_perm:[1,0,3,2] row_mask:0xf bank_mask:0xf
    s_nop 1
    v_max_f32_dpp v20, v20, v20 quad_perm:[2,3,0,1] row_mask:0xf bank_mask:0xf
    v_max_f32_dpp v21, v21, v21 quad_perm:[2,3,0,1] row_mask:0xf bank_mask:0xf
    s_nop 1
    v_max_f32_dpp v20, v20, v20 row_half_mirror row_mask:0xf bank_mask:0xf
    v_max_f32_dpp v21, v21, v21 row_half_mirror row_mask:0xf bank_mask:0xf
    s_nop 1
    v_max_f32_dpp v20, v20, v20 row_mirror row_mask:0xf bank_mask:0xf
    v_max_f32_dpp v21, v21, v21 row_mirror row_mask:0xf bank_mask:0xf
    s_mov_b32 s88, 0x3fb8aa3b
    v_sub_f32 v22, v128, v20
    v_mul_f32 v22, s88, v22
    v_exp_f32 v22, v22
    v_sub_f32 v23, v164, v21
    v_mul_f32 v23, s88, v23
    v_exp_f32 v23, v23
    s_nop 0
    v_mul_f32 v24, v129, v22
    v_mul_f32 v25, v165, v23
    s_nop 1
    v_add_f32_dpp v24, v24, v24 quad_perm:[1,0,3,2] row_mask:0xf bank_mask:0xf
    v_add_f32_dpp v25, v25, v25 quad_perm:[1,0,3,2] row_mask:0xf bank_mask:0xf
    s_nop 1
    v_add_f32_dpp v24, v24, v24 quad_perm:[2,3,0,1] row_mask:0xf bank_mask:0xf
    v_add_f32_dpp v25, v25, v25 quad_perm:[2,3,0,1] row_mask:0xf bank_mask:0xf
    s_nop 1
    v_add_f32_dpp v24, v24, v24 row_half_mirror row_mask:0xf bank_mask:0xf
    v_add_f32_dpp v25, v25, v25 row_half_mirror row_mask:0xf bank_mask:0xf
    s_nop 1
    v_add_f32_dpp v24, v24, v24 row_mirror row_mask:0xf bank_mask:0xf
    v_add_f32_dpp v25, v25, v25 row_mirror row_mask:0xf bank_mask:0xf
    v_lshlrev_b32 v9, 5, v6
    v_add_u32 v26, 0, v9
    v_add_u32 v27, 4, v9
    v_add_u32 v28, 8, v9
    v_add_u32 v29, 12, v9
    v_add_u32 v30, 16, v9
    v_add_u32 v31, 20, v9
    v_add_u32 v32, 24, v9
    v_add_u32 v33, 28, v9
    ds_bpermute_b32 v34, v26, v22
    ds_bpermute_b32 v35, v27, v22
    ds_bpermute_b32 v36, v28, v22
    ds_bpermute_b32 v37, v29, v22
    ds_bpermute_b32 v38, v30, v22
    ds_bpermute_b32 v39, v31, v22
    ds_bpermute_b32 v40, v32, v22
    ds_bpermute_b32 v41, v33, v22
    ds_bpermute_b32 v42, v26, v23
    ds_bpermute_b32 v43, v27, v23
    ds_bpermute_b32 v44, v28, v23
    ds_bpermute_b32 v45, v29, v23
    ds_bpermute_b32 v46, v30, v23
    ds_bpermute_b32 v47, v31, v23
    ds_bpermute_b32 v48, v32, v23
    ds_bpermute_b32 v49, v33, v23
    s_waitcnt lgkmcnt(0)
    v_mul_f32 v50, v132, v34
    v_mul_f32 v51, v133, v34
    v_mul_f32 v52, v134, v34
    v_mul_f32 v53, v135, v34
    v_fmac_f32 v50, v136, v35
    v_fmac_f32 v51, v137, v35
    v_fmac_f32 v52, v138, v35
    v_fmac_f32 v53, v139, v35
    v_fmac_f32 v50, v140, v36
    v_fmac_f32 v51, v141, v36
    v_fmac_f32 v52, v142, v36
    v_fmac_f32 v53, v143, v36
    v_fmac_f32 v50, v144, v37
    v_fmac_f32 v51, v145, v37
    v_fmac_f32 v52, v146, v37
    v_fmac_f32 v53, v147, v37
    v_fmac_f32 v50, v148, v38
    v_fmac_f32 v51, v149, v38
    v_fmac_f32 v52, v150, v38
    v_fmac_f32 v53, v151, v38
    v_fmac_f32 v50, v152, v39
    v_fmac_f32 v51, v153, v39
    v_fmac_f32 v52, v154, v39
    v_fmac_f32 v53, v155, v39
    v_fmac_f32 v50, v156, v40
    v_fmac_f32 v51, v157, v40
    v_fmac_f32 v52, v158, v40
    v_fmac_f32 v53, v159, v40
    v_fmac_f32 v50, v160, v41
    v_fmac_f32 v51, v161, v41
    v_fmac_f32 v52, v162, v41
    v_fmac_f32 v53, v163, v41
    v_mul_f32 v54, v168, v42
    v_mul_f32 v55, v169, v42
    v_mul_f32 v56, v170, v42
    v_mul_f32 v57, v171, v42
    v_fmac_f32 v54, v172, v43
    v_fmac_f32 v55, v173, v43
    v_fmac_f32 v56, v174, v43
    v_fmac_f32 v57, v175, v43
    v_fmac_f32 v54, v176, v44
    v_fmac_f32 v55, v177, v44
    v_fmac_f32 v56, v178, v44
    v_fmac_f32 v57, v179, v44
    v_fmac_f32 v54, v180, v45
    v_fmac_f32 v55, v181, v45
    v_fmac_f32 v56, v182, v45
    v_fmac_f32 v57, v183, v45
    v_fmac_f32 v54, v184, v46
    v_fmac_f32 v55, v185, v46
    v_fmac_f32 v56, v186, v46
    v_fmac_f32 v57, v187, v46
    v_fmac_f32 v54, v188, v47
    v_fmac_f32 v55, v189, v47
    v_fmac_f32 v56, v190, v47
    v_fmac_f32 v57, v191, v47
    v_fmac_f32 v54, v192, v48
    v_fmac_f32 v55, v193, v48
    v_fmac_f32 v56, v194, v48
    v_fmac_f32 v57, v195, v48
    v_fmac_f32 v54, v196, v49
    v_fmac_f32 v55, v197, v49
    v_fmac_f32 v56, v198, v49
    v_fmac_f32 v57, v199, v49
    v_mov_b32 v26, v50
    v_mov_b32 v27, v51
    v_mov_b32 v28, v52
    v_mov_b32 v29, v53
    v_mov_b32 v30, v54
    v_mov_b32 v31, v55
    v_mov_b32 v32, v56
    v_mov_b32 v33, v57
    s_nop 1
    v_permlane32_swap_b32 v50, v26
    v_permlane32_swap_b32 v51, v27
    v_permlane32_swap_b32 v52, v28
    v_permlane32_swap_b32 v53, v29
    v_permlane32_swap_b32 v54, v30
    v_permlane32_swap_b32 v55, v31
    v_permlane32_swap_b32 v56, v32
    v_permlane32_swap_b32 v57, v33
    s_nop 1
    v_add_f32 v50, v50, v26
    v_add_f32 v51, v51, v27
    v_add_f32 v52, v52, v28
    v_add_f32 v53, v53, v29
    v_add_f32 v54, v54, v30
    v_add_f32 v55, v55, v31
    v_add_f32 v56, v56, v32
    v_add_f32 v57, v57, v33
    v_rcp_f32 v20, v24
    v_rcp_f32 v21, v25
    s_nop 0
    v_mul_f32 v26, v50, v20
    v_fma_f32 v27, -v26, v24, v50
    v_fma_f32 v50, v27, v20, v26
    v_mul_f32 v26, v51, v20
    v_fma_f32 v27, -v26, v24, v51
    v_fma_f32 v51, v27, v20, v26
    v_mul_f32 v26, v52, v20
    v_fma_f32 v27, -v26, v24, v52
    v_fma_f32 v52, v27, v20, v26
    v_mul_f32 v26, v53, v20
    v_fma_f32 v27, -v26, v24, v53
    v_fma_f32 v53, v27, v20, v26
    v_mul_f32 v26, v54, v21
    v_fma_f32 v27, -v26, v25, v54
    v_fma_f32 v54, v27, v21, v26
    v_mul_f32 v26, v55, v21
    v_fma_f32 v27, -v26, v25, v55
    v_fma_f32 v55, v27, v21, v26
    v_mul_f32 v26, v56, v21
    v_fma_f32 v27, -v26, v25, v56
    v_fma_f32 v56, v27, v21, v26
    v_mul_f32 v26, v57, v21
    v_fma_f32 v27, -v26, v25, v57
    v_fma_f32 v57, v27, v21, v26
    v_cvt_pk_bf16_f32 v28, v50, v51
    v_cvt_pk_bf16_f32 v29, v52, v53
    v_cvt_pk_bf16_f32 v30, v54, v55
    v_cvt_pk_bf16_f32 v31, v56, v57
    v_lshlrev_b32 v3, 1, v7
    v_add_u32 v3, 152576, v3
    ds_write_b16 v3, v28 offset:0
    ds_write_b16_d16_hi v3, v28 offset:64
    ds_write_b16 v3, v29 offset:128
    ds_write_b16_d16_hi v3, v29 offset:192
    ds_write_b16 v3, v30 offset:256
    ds_write_b16_d16_hi v3, v30 offset:320
    ds_write_b16 v3, v31 offset:384
    ds_write_b16_d16_hi v3, v31 offset:448
    v_and_b32 v3, 1, v0
    v_lshlrev_b32 v3, 8, v3
    v_lshrrev_b32 v4, 4, v0
    v_lshl_add_u32 v3, v4, 4, v3
    v_add_u32 v3, 152576, v3
    s_waitcnt lgkmcnt(0)
    ds_read_b128 v[32:35], v3 offset:0
    ds_read_b128 v[36:39], v3 offset:64
    ds_read_b128 v[40:43], v3 offset:128
    ds_read_b128 v[44:47], v3 offset:192
    s_waitcnt lgkmcnt(0)
    v_mfma_f32_16x16x32_bf16 v[48:51], v[32:35], v[64:67], 0
    v_mfma_f32_16x16x32_bf16 v[52:55], v[32:35], v[68:71], 0
    v_mfma_f32_16x16x32_bf16 v[56:59], v[32:35], v[72:75], 0
    v_mfma_f32_16x16x32_bf16 v[60:63], v[32:35], v[76:79], 0
    v_mfma_f32_16x16x32_bf16 v[48:51], v[36:39], v[80:83], v[48:51]
    v_mfma_f32_16x16x32_bf16 v[52:55], v[36:39], v[84:87], v[52:55]
    v_mfma_f32_16x16x32_bf16 v[56:59], v[36:39], v[88:91], v[56:59]
    v_mfma_f32_16x16x32_bf16 v[60:63], v[36:39], v[92:95], v[60:63]
    v_mfma_f32_16x16x32_bf16 v[48:51], v[40:43], v[96:99], v[48:51]
    v_mfma_f32_16x16x32_bf16 v[52:55], v[40:43], v[100:103], v[52:55]
    v_mfma_f32_16x16x32_bf16 v[56:59], v[40:43], v[104:107], v[56:59]
    v_mfma_f32_16x16x32_bf16 v[60:63], v[40:43], v[108:111], v[60:63]
    v_mfma_f32_16x16x32_bf16 v[48:51], v[44:47], v[112:115], v[48:51]
    v_mfma_f32_16x16x32_bf16 v[52:55], v[44:47], v[116:119], v[52:55]
    v_mfma_f32_16x16x32_bf16 v[56:59], v[44:47], v[120:123], v[56:59]
    v_mfma_f32_16x16x32_bf16 v[60:63], v[44:47], v[124:127], v[60:63]
    s_nop 7
    s_nop 1
    v_mov_b32 v4, v48
    v_mov_b32 v5, v52
    v_mov_b32 v6, v56
    v_mov_b32 v7, v60
    v_mov_b32 v8, v49
    v_mov_b32 v9, v53
    v_mov_b32 v10, v57
    v_mov_b32 v11, v61
    v_add_u32 v4, 0x80, v4
    v_bfi_b32 v4, v15, s16, v4
    v_add_u32 v5, 0x80, v5
    v_bfi_b32 v5, v15, s17, v5
    v_add_u32 v6, 0x80, v6
    v_bfi_b32 v6, v15, s18, v6
    v_add_u32 v7, 0x80, v7
    v_bfi_b32 v7, v15, s19, v7
    v_add_u32 v8, 0x80, v8
    v_bfi_b32 v8, v15, s16, v8
    v_add_u32 v9, 0x80, v9
    v_bfi_b32 v9, v15, s17, v9
    v_add_u32 v10, 0x80, v10
    v_bfi_b32 v10, v15, s18, v10
    v_add_u32 v11, 0x80, v11
    v_bfi_b32 v11, v15, s19, v11
    v_lshlrev_b32 v1, 4, v0
    s_lshl_b32 s88, s2, 9
    s_add_u32 s88, s88, 1032192
    s_mov_b64 exec, 0xffff
    buffer_store_dwordx4 v[4:7], v1, s[80:83], s88 offen sc1
    buffer_store_dwordx4 v[8:11], v1, s[80:83], s88 offen offset:256 sc1
    s_mov_b64 exec, -1
    s_and_b32 s88, s2, 15
    s_lshl_b32 s88, s88, 1
    s_lshl_b32 s89, s4, 7
    s_add_u32 s88, s88, s89
    s_lshl_b32 s89, s5, 10
    s_add_u32 s91, s88, s89
    v_mov_b32 v20, s91
    buffer_load_ushort v22, v20, s[40:43], 0 offen offset:0
    buffer_load_ushort v23, v20, s[40:43], 0 offen offset:32
    buffer_load_ushort v24, v20, s[40:43], 0 offen offset:64
    buffer_load_ushort v25, v20, s[40:43], 0 offen offset:96
    v_and_b32 v1, 31, v0
    v_lshlrev_b32 v1, 9, v1
    v_lshrrev_b32 v2, 5, v0
    v_lshl_add_u32 v1, v2, 17, v1
    s_lshl_b32 s88, s4, 14
    s_lshl_b32 s89, s5, 8
    s_add_u32 s88, s88, s89
    s_and_b32 s89, s2, 15
    s_lshl_b32 s89, s89, 4
    s_add_u32 s88, s88, s89
    s_add_u32 s88, s88, 1032192
    s_mov_b32 s14, 0
L_og:
    buffer_load_dwordx4 v[4:7], v1, s[80:83], s88 offen sc1
    s_waitcnt vmcnt(0)
    v_xor_b32 v9, s16, v4
    v_xor_b32 v10, s17, v5
    v_or_b32 v8, v9, v10
    v_xor_b32 v9, s18, v6
    v_xor_b32 v10, s19, v7
    v_or3_b32 v8, v8, v9, v10
    v_and_b32 v8, 0xff, v8
    v_cmp_ne_u32 vcc, 0, v8
    s_nop 4
    s_cbranch_vccz L_og_ok
    s_sleep 1
    s_add_u32 s14, s14, 1
    s_cmp_lt_u32 s14, 400000
    s_cbranch_scc1 L_og
L_og_ok:
    v_and_b32 v4, 0xffffff00, v4
    v_and_b32 v5, 0xffffff00, v5
    v_and_b32 v6, 0xffffff00, v6
    v_and_b32 v7, 0xffffff00, v7
    s_nop 1
    v_add_f32_dpp v4, v4, v4 quad_perm:[1,0,3,2] row_mask:0xf bank_mask:0xf
    v_add_f32_dpp v5, v5, v5 quad_perm:[1,0,3,2] row_mask:0xf bank_mask:0xf
    v_add_f32_dpp v6, v6, v6 quad_perm:[1,0,3,2] row_mask:0xf bank_mask:0xf
    v_add_f32_dpp v7, v7, v7 quad_perm:[1,0,3,2] row_mask:0xf bank_mask:0xf
    s_nop 1
    v_add_f32_dpp v4, v4, v4 quad_perm:[2,3,0,1] row_mask:0xf bank_mask:0xf
    v_add_f32_dpp v5, v5, v5 quad_perm:[2,3,0,1] row_mask:0xf bank_mask:0xf
    v_add_f32_dpp v6, v6, v6 quad_perm:[2,3,0,1] row_mask:0xf bank_mask:0xf
    v_add_f32_dpp v7, v7, v7 quad_perm:[2,3,0,1] row_mask:0xf bank_mask:0xf
    s_nop 1
    v_add_f32_dpp v4, v4, v4 row_half_mirror row_mask:0xf bank_mask:0xf
    v_add_f32_dpp v5, v5, v5 row_half_mirror row_mask:0xf bank_mask:0xf
    v_add_f32_dpp v6, v6, v6 row_half_mirror row_mask:0xf bank_mask:0xf
    v_add_f32_dpp v7, v7, v7 row_half_mirror row_mask:0xf bank_mask:0xf
    s_nop 1
    v_add_f32_dpp v4, v4, v4 row_mirror row_mask:0xf bank_mask:0xf
    v_add_f32_dpp v5, v5, v5 row_mirror row_mask:0xf bank_mask:0xf
    v_add_f32_dpp v6, v6, v6 row_mirror row_mask:0xf bank_mask:0xf
    v_add_f32_dpp v7, v7, v7 row_mirror row_mask:0xf bank_mask:0xf
    v_mov_b32 v8, v4
    v_mov_b32 v9, v5
    v_mov_b32 v10, v6
    v_mov_b32 v11, v7
    s_nop 1
    v_permlane16_swap_b32 v4, v8
    v_permlane16_swap_b32 v5, v9
    v_permlane16_swap_b32 v6, v10
    v_permlane16_swap_b32 v7, v11
    s_nop 1
    v_add_f32 v4, v4, v8
    v_add_f32 v5, v5, v9
    v_add_f32 v6, v6, v10
    v_add_f32 v7, v7, v11
    v_cvt_pk_bf16_f32 v12, v4, v5
    v_lshlrev_b32 v4, 16, v12
    v_and_b32 v5, 0xffff0000, v12
    v_cvt_pk_bf16_f32 v12, v6, v7
    v_lshlrev_b32 v6, 16, v12
    v_and_b32 v7, 0xffff0000, v12
    v_mov_b32 v8, v4
    v_mov_b32 v9, v5
    v_mov_b32 v10, v6
    v_mov_b32 v11, v7
    s_nop 1
    v_permlane32_swap_b32 v4, v8
    v_permlane32_swap_b32 v5, v9
    v_permlane32_swap_b32 v6, v10
    v_permlane32_swap_b32 v7, v11
    s_nop 1
    v_lshlrev_b32 v22, 16, v22
    v_add_f32 v4, v22, v4
    v_lshlrev_b32 v23, 16, v23
    v_add_f32 v5, v23, v5
    v_lshlrev_b32 v24, 16, v24
    v_add_f32 v6, v24, v6
    v_lshlrev_b32 v25, 16, v25
    v_add_f32 v7, v25, v7
    v_cvt_pk_bf16_f32 v12, v4, v5
    v_lshlrev_b32 v4, 16, v12
    v_and_b32 v5, 0xffff0000, v12
    v_cvt_pk_bf16_f32 v12, v6, v7
    v_lshlrev_b32 v6, 16, v12
    v_and_b32 v7, 0xffff0000, v12
    v_add_f32 v4, v4, v8
    v_add_f32 v5, v5, v9
    v_add_f32 v6, v6, v10
    v_add_f32 v7, v7, v11
    v_cvt_pk_bf16_f32 v12, v4, v5
    v_cvt_pk_bf16_f32 v13, v6, v7
    s_mov_b64 exec, 1
    buffer_store_short v12, v20, s[72:75], 0 offen
    buffer_store_short_d16_hi v12, v20, s[72:75], 0 offen offset:32
    buffer_store_short v13, v20, s[72:75], 0 offen offset:64
    buffer_store_short_d16_hi v13, v20, s[72:75], 0 offen offset:96
    s_branch L_end
L_aux_ffn:
    s_mul_i32 s88, s6, 57344
    s_add_u32 s88, s88, s89
    buffer_load_dwordx4 v[128:131], v12, s[68:71], s88 offen nt
    s_add_u32 s88, s88, 8192
    buffer_load_dwordx4 v[132:135], v12, s[68:71], s88 offen nt
    s_add_u32 s88, s88, 8192
    buffer_load_dwordx4 v[136:139], v12, s[68:71], s88 offen nt
    s_add_u32 s88, s88, 8192
    buffer_load_dwordx4 v[140:143], v12, s[68:71], s88 offen nt
    s_add_u32 s88, s88, 8192
    buffer_load_dwordx4 v[144:147], v12, s[68:71], s88 offen nt
    s_add_u32 s88, s88, 8192
    buffer_load_dwordx4 v[148:151], v12, s[68:71], s88 offen nt
    s_add_u32 s88, s88, 8192
    buffer_load_dwordx4 v[152:155], v12, s[68:71], s88 offen nt
    v_mov_b32 v5, 153128
    s_mov_b32 s90, 0
L_fw:
    ds_read_b32 v6, v5
    s_waitcnt lgkmcnt(0)
    v_readfirstlane_b32 s88, v6
    s_add_u32 s90, s90, 1
    s_cmp_eq_u32 s88, s92
    s_cbranch_scc1 L_fw_ok
    s_sleep 4
    s_cmp_lt_u32 s90, 3200000
    s_cbranch_scc1 L_fw
L_fw_ok:
    s_mov_b64 exec, 0xffff
    v_min_u32 v1, 13, v0
    v_lshlrev_b32 v2, 4, v1
    s_sub_u32 s89, s3, 2
    s_mul_i32 s88, s89, 14336
    s_mul_i32 s91, s6, 224
    s_add_u32 s88, s88, s91
    s_add_u32 s90, s88, 262144
L_hg:
    s_mov_b32 s88, s90
    buffer_load_dwordx4 v[64:67], v2, s[80:83], s88 offen sc1
    s_add_u32 s91, s88, 7168
    buffer_load_dwordx4 v[68:71], v2, s[80:83], s91 offen sc1
    s_add_u32 s88, s88, 28672
    buffer_load_dwordx4 v[72:75], v2, s[80:83], s88 offen sc1
    s_add_u32 s91, s88, 7168
    buffer_load_dwordx4 v[76:79], v2, s[80:83], s91 offen sc1
    s_add_u32 s88, s88, 28672
    buffer_load_dwordx4 v[80:83], v2, s[80:83], s88 offen sc1
    s_add_u32 s91, s88, 7168
    buffer_load_dwordx4 v[84:87], v2, s[80:83], s91 offen sc1
    s_add_u32 s88, s88, 28672
    buffer_load_dwordx4 v[88:91], v2, s[80:83], s88 offen sc1
    s_add_u32 s91, s88, 7168
    buffer_load_dwordx4 v[92:95], v2, s[80:83], s91 offen sc1
    s_add_u32 s88, s88, 28672
    buffer_load_dwordx4 v[96:99], v2, s[80:83], s88 offen sc1
    s_add_u32 s91, s88, 7168
    buffer_load_dwordx4 v[100:103], v2, s[80:83], s91 offen sc1
    s_add_u32 s88, s88, 28672
    buffer_load_dwordx4 v[104:107], v2, s[80:83], s88 offen sc1
    s_add_u32 s91, s88, 7168
    buffer_load_dwordx4 v[108:111], v2, s[80:83], s91 offen sc1
    s_add_u32 s88, s88, 28672
    buffer_load_dwordx4 v[112:115], v2, s[80:83], s88 offen sc1
    s_add_u32 s91, s88, 7168
    buffer_load_dwordx4 v[116:119], v2, s[80:83], s91 offen sc1
    s_add_u32 s88, s88, 28672
    buffer_load_dwordx4 v[120:123], v2, s[80:83], s88 offen sc1
    s_add_u32 s91, s88, 7168
    buffer_load_dwordx4 v[124:127], v2, s[80:83], s91 offen sc1
    s_waitcnt vmcnt(0)
    v_xor_b32 v5, s16, v64
    v_xor_b32 v6, s17, v65
    v_or_b32 v4, v5, v6
    v_xor_b32 v5, s18, v66
    v_xor_b32 v6, s19, v67
    v_or3_b32 v4, v4, v5, v6
    v_xor_b32 v5, s16, v68
    v_xor_b32 v6, s17, v69
    v_or3_b32 v4, v4, v5, v6
    v_xor_b32 v5, s18, v70
    v_xor_b32 v6, s19, v71
    v_or3_b32 v4, v4, v5, v6
    v_xor_b32 v5, s16, v72
    v_xor_b32 v6, s17, v73
    v_or3_b32 v4, v4, v5, v6
    v_xor_b32 v5, s18, v74
    v_xor_b32 v6, s19, v75
    v_or3_b32 v4, v4, v5, v6
    v_xor_b32 v5, s16, v76
    v_xor_b32 v6, s17, v77
    v_or3_b32 v4, v4, v5, v6
    v_xor_b32 v5, s18, v78
    v_xor_b32 v6, s19, v79
    v_or3_b32 v4, v4, v5, v6
    v_xor_b32 v5, s16, v80
    v_xor_b32 v6, s17, v81
    v_or3_b32 v4, v4, v5, v6
    v_xor_b32 v5, s18, v82
    v_xor_b32 v6, s19, v83
    v_or3_b32 v4, v4, v5, v6
    v_xor_b32 v5, s16, v84
    v_xor_b32 v6, s17, v85
    v_or3_b32 v4, v4, v5, v6
    v_xor_b32 v5, s18, v86
    v_xor_b32 v6, s19, v87
    v_or3_b32 v4, v4, v5, v6
    v_xor_b32 v5, s16, v88
    v_xor_b32 v6, s17, v89
    v_or3_b32 v4, v4, v5, v6
    v_xor_b32 v5, s18, v90
    v_xor_b32 v6, s19, v91
    v_or3_b32 v4, v4, v5, v6
    v_xor_b32 v5, s16, v92
    v_xor_b32 v6, s17, v93
    v_or3_b32 v4, v4, v5, v6
    v_xor_b32 v5, s18, v94
    v_xor_b32 v6, s19, v95
    v_or3_b32 v4, v4, v5, v6
    v_xor_b32 v5, s16, v96
    v_xor_b32 v6, s17, v97
    v_or3_b32 v4, v4, v5, v6
    v_xor_b32 v5, s18, v98
    v_xor_b32 v6, s19, v99
    v_or3_b32 v4, v4, v5, v6
    v_xor_b32 v5, s16, v100
    v_xor_b32 v6, s17, v101
    v_or3_b32 v4, v4, v5, v6
    v_xor_b32 v5, s18, v102
    v_xor_b32 v6, s19, v103
    v_or3_b32 v4, v4, v5, v6
    v_xor_b32 v5, s16, v104
    v_xor_b32 v6, s17, v105
    v_or3_b32 v4, v4, v5, v6
    v_xor_b32 v5, s18, v106
    v_xor_b32 v6, s19, v107
    v_or3_b32 v4, v4, v5, v6
    v_xor_b32 v5, s16, v108
    v_xor_b32 v6, s17, v109
    v_or3_b32 v4, v4, v5, v6
    v_xor_b32 v5, s18, v110
    v_xor_b32 v6, s19, v111
    v_or3_b32 v4, v4, v5, v6
    v_xor_b32 v5, s16, v112
    v_xor_b32 v6, s17, v113
    v_or3_b32 v4, v4, v5, v6
    v_xor_b32 v5, s18, v114
    v_xor_b32 v6, s19, v115
    v_or3_b32 v4, v4, v5, v6
    v_xor_b32 v5, s16, v116
    v_xor_b32 v6, s17, v117
    v_or3_b32 v4, v4, v5, v6
    v_xor_b32 v5, s18, v118
    v_xor_b32 v6, s19, v119
    v_or3_b32 v4, v4, v5, v6
    v_xor_b32 v5, s16, v120
    v_xor_b32 v6, s17, v121
    v_or3_b32 v4, v4, v5, v6
    v_xor_b32 v5, s18, v122
    v_xor_b32 v6, s19, v123
    v_or3_b32 v4, v4, v5, v6
    v_xor_b32 v5, s16, v124
    v_xor_b32 v6, s17, v125
    v_or3_b32 v4, v4, v5, v6
    v_xor_b32 v5, s18, v126
    v_xor_b32 v6, s19, v127
    v_or3_b32 v4, v4, v5, v6
    v_and_b32 v4, 0xff, v4
    v_cmp_ne_u32 vcc, 0, v4
    s_nop 4
    s_cbranch_vccz L_hg_ok
    s_sleep 1
    s_add_u32 s14, s14, 1
    s_cmp_lt_u32 s14, 400000
    s_cbranch_scc1 L_hg
L_hg_ok:
    v_and_b32 v64, 0xffffff00, v64
    v_and_b32 v65, 0xffffff00, v65
    v_and_b32 v66, 0xffffff00, v66
    v_and_b32 v67, 0xffffff00, v67
    v_and_b32 v68, 0xffffff00, v68
    v_and_b32 v69, 0xffffff00, v69
    v_and_b32 v70, 0xffffff00, v70
    v_and_b32 v71, 0xffffff00, v71
    v_and_b32 v72, 0xffffff00, v72
    v_and_b32 v73, 0xffffff00, v73
    v_and_b32 v74, 0xffffff00, v74
    v_and_b32 v75, 0xffffff00, v75
    v_and_b32 v76, 0xffffff00, v76
    v_and_b32 v77, 0xffffff00, v77
    v_and_b32 v78, 0xffffff00, v78
    v_and_b32 v79, 0xffffff00, v79
    v_and_b32 v80, 0xffffff00, v80
    v_and_b32 v81, 0xffffff00, v81
    v_and_b32 v82, 0xffffff00, v82
    v_and_b32 v83, 0xffffff00, v83
    v_and_b32 v84, 0xffffff00, v84
    v_and_b32 v85, 0xffffff00, v85
    v_and_b32 v86, 0xffffff00, v86
    v_and_b32 v87, 0xffffff00, v87
    v_and_b32 v88, 0xffffff00, v88
    v_and_b32 v89, 0xffffff00, v89
    v_and_b32 v90, 0xffffff00, v90
    v_and_b32 v91, 0xffffff00, v91
    v_and_b32 v92, 0xffffff00, v92
    v_and_b32 v93, 0xffffff00, v93
    v_and_b32 v94, 0xffffff00, v94
    v_and_b32 v95, 0xffffff00, v95
    v_and_b32 v96, 0xffffff00, v96
    v_and_b32 v97, 0xffffff00, v97
    v_and_b32 v98, 0xffffff00, v98
    v_and_b32 v99, 0xffffff00, v99
    v_and_b32 v100, 0xffffff00, v100
    v_and_b32 v101, 0xffffff00, v101
    v_and_b32 v102, 0xffffff00, v102
    v_and_b32 v103, 0xffffff00, v103
    v_and_b32 v104, 0xffffff00, v104
    v_and_b32 v105, 0xffffff00, v105
    v_and_b32 v106, 0xffffff00, v106
    v_and_b32 v107, 0xffffff00, v107
    v_and_b32 v108, 0xffffff00, v108
    v_and_b32 v109, 0xffffff00, v109
    v_and_b32 v110, 0xffffff00, v110
    v_and_b32 v111, 0xffffff00, v111
    v_and_b32 v112, 0xffffff00, v112
    v_and_b32 v113, 0xffffff00, v113
    v_and_b32 v114, 0xffffff00, v114
    v_and_b32 v115, 0xffffff00, v115
    v_and_b32 v116, 0xffffff00, v116
    v_and_b32 v117, 0xffffff00, v117
    v_and_b32 v118, 0xffffff00, v118
    v_and_b32 v119, 0xffffff00, v119
    v_and_b32 v120, 0xffffff00, v120
    v_and_b32 v121, 0xffffff00, v121
    v_and_b32 v122, 0xffffff00, v122
    v_and_b32 v123, 0xffffff00, v123
    v_and_b32 v124, 0xffffff00, v124
    v_and_b32 v125, 0xffffff00, v125
    v_and_b32 v126, 0xffffff00, v126
    v_and_b32 v127, 0xffffff00, v127
    v_add_f32 v64, v64, v72
    v_add_f32 v65, v65, v73
    v_add_f32 v66, v66, v74
    v_add_f32 v67, v67, v75
    v_add_f32 v68, v68, v76
    v_add_f32 v69, v69, v77
    v_add_f32 v70, v70, v78
    v_add_f32 v71, v71, v79
    v_add_f32 v64, v64, v80
    v_add_f32 v65, v65, v81
    v_add_f32 v66, v66, v82
    v_add_f32 v67, v67, v83
    v_add_f32 v68, v68, v84
    v_add_f32 v69, v69, v85
    v_add_f32 v70, v70, v86
    v_add_f32 v71, v71, v87
    v_add_f32 v64, v64, v88
    v_add_f32 v65, v65, v89
    v_add_f32 v66, v66, v90
    v_add_f32 v67, v67, v91
    v_add_f32 v68, v68, v92
    v_add_f32 v69, v69, v93
    v_add_f32 v70, v70, v94
    v_add_f32 v71, v71, v95
    v_add_f32 v64, v64, v96
    v_add_f32 v65, v65, v97
    v_add_f32 v66, v66, v98
    v_add_f32 v67, v67, v99
    v_add_f32 v68, v68, v100
    v_add_f32 v69, v69, v101
    v_add_f32 v70, v70, v102
    v_add_f32 v71, v71, v103
    v_add_f32 v64, v64, v104
    v_add_f32 v65, v65, v105
    v_add_f32 v66, v66, v106
    v_add_f32 v67, v67, v107
    v_add_f32 v68, v68, v108
    v_add_f32 v69, v69, v109
    v_add_f32 v70, v70, v110
    v_add_f32 v71, v71, v111
    v_add_f32 v64, v64, v112
    v_add_f32 v65, v65, v113
    v_add_f32 v66, v66, v114
    v_add_f32 v67, v67, v115
    v_add_f32 v68, v68, v116
    v_add_f32 v69, v69, v117
    v_add_f32 v70, v70, v118
    v_add_f32 v71, v71, v119
    v_add_f32 v64, v64, v120
    v_add_f32 v65, v65, v121
    v_add_f32 v66, v66, v122
    v_add_f32 v67, v67, v123
    v_add_f32 v68, v68, v124
    v_add_f32 v69, v69, v125
    v_add_f32 v70, v70, v126
    v_add_f32 v71, v71, v127
    v_cvt_pk_bf16_f32 v42, v64, v65
    v_lshlrev_b32 v64, 16, v42
    v_and_b32 v65, 0xffff0000, v42
    v_cvt_pk_bf16_f32 v42, v66, v67
    v_lshlrev_b32 v66, 16, v42
    v_and_b32 v67, 0xffff0000, v42
    v_cvt_pk_bf16_f32 v42, v68, v69
    v_lshlrev_b32 v68, 16, v42
    v_and_b32 v69, 0xffff0000, v42
    v_cvt_pk_bf16_f32 v42, v70, v71
    v_lshlrev_b32 v70, 16, v42
    v_and_b32 v71, 0xffff0000, v42
    s_mov_b32 s88, 0xbfb8aa3b
    v_mul_f32 v72, s88, v64
    v_exp_f32 v72, v72
    s_nop 0
    v_add_f32 v72, 1.0, v72
    v_rcp_f32 v73, v72
    s_nop 0
    v_mul_f32 v74, v64, v73
    v_fma_f32 v75, -v74, v72, v64
    v_fmac_f32 v74, v75, v73
    v_mov_b32 v64, v74
    v_mul_f32 v72, s88, v65
    v_exp_f32 v72, v72
    s_nop 0
    v_add_f32 v72, 1.0, v72
    v_rcp_f32 v73, v72
    s_nop 0
    v_mul_f32 v74, v65, v73
    v_fma_f32 v75, -v74, v72, v65
    v_fmac_f32 v74, v75, v73
    v_mov_b32 v65, v74
    v_mul_f32 v72, s88, v66
    v_exp_f32 v72, v72
    s_nop 0
    v_add_f32 v72, 1.0, v72
    v_rcp_f32 v73, v72
    s_nop 0
    v_mul_f32 v74, v66, v73
    v_fma_f32 v75, -v74, v72, v66
    v_fmac_f32 v74, v75, v73
    v_mov_b32 v66, v74
    v_mul_f32 v72, s88, v67
    v_exp_f32 v72, v72
    s_nop 0
    v_add_f32 v72, 1.0, v72
    v_rcp_f32 v73, v72
    s_nop 0
    v_mul_f32 v74, v67, v73
    v_fma_f32 v75, -v74, v72, v67
    v_fmac_f32 v74, v75, v73
    v_mov_b32 v67, v74
    v_cvt_pk_bf16_f32 v42, v64, v65
    v_lshlrev_b32 v64, 16, v42
    v_and_b32 v65, 0xffff0000, v42
    v_cvt_pk_bf16_f32 v42, v66, v67
    v_lshlrev_b32 v66, 16, v42
    v_and_b32 v67, 0xffff0000, v42
    v_mul_f32 v64, v64, v68
    v_mul_f32 v65, v65, v69
    v_mul_f32 v66, v66, v70
    v_mul_f32 v67, v67, v71
    v_cvt_pk_bf16_f32 v42, v64, v65
    v_lshlrev_b32 v64, 16, v42
    v_and_b32 v65, 0xffff0000, v42
    v_cvt_pk_bf16_f32 v42, v66, v67
    v_lshlrev_b32 v66, 16, v42
    v_and_b32 v67, 0xffff0000, v42
    v_lshlrev_b32 v3, 4, v0
    v_add_u32 v3, s11, v3
    ds_write_b128 v3, v[64:67] offset:2048
    s_mov_b64 exec, -1
    s_waitcnt lgkmcnt(0)
    v_lshlrev_b32 v3, 2, v10
    v_add_u32 v3, s11, v3
    ds_read_b32 v20, v3 offset:2048
    ds_read_b32 v21, v3 offset:2080
    ds_read_b32 v22, v3 offset:2112
    ds_read_b32 v23, v3 offset:2144
    ds_read_b32 v24, v3 offset:2176
    ds_read_b32 v25, v3 offset:2208
    ds_read_b32 v26, v3 offset:2240
    s_waitcnt lgkmcnt(0)
    v_lshlrev_b32 v52, 16, v128
    v_and_b32 v53, 0xffff0000, v128
    v_mul_f32 v36, v52, v20
    v_mul_f32 v37, v53, v20
    v_lshlrev_b32 v52, 16, v129
    v_and_b32 v53, 0xffff0000, v129
    v_mul_f32 v38, v52, v20
    v_mul_f32 v39, v53, v20
    v_lshlrev_b32 v52, 16, v130
    v_and_b32 v53, 0xffff0000, v130
    v_mul_f32 v40, v52, v20
    v_mul_f32 v41, v53, v20
    v_lshlrev_b32 v52, 16, v131
    v_and_b32 v53, 0xffff0000, v131
    v_mul_f32 v42, v52, v20
    v_mul_f32 v43, v53, v20
    v_lshlrev_b32 v52, 16, v132
    v_and_b32 v53, 0xffff0000, v132
    v_fmac_f32 v36, v52, v21
    v_fmac_f32 v37, v53, v21
    v_lshlrev_b32 v52, 16, v133
    v_and_b32 v53, 0xffff0000, v133
    v_fmac_f32 v38, v52, v21
    v_fmac_f32 v39, v53, v21
    v_lshlrev_b32 v52, 16, v134
    v_and_b32 v53, 0xffff0000, v134
    v_fmac_f32 v40, v52, v21
    v_fmac_f32 v41, v53, v21
    v_lshlrev_b32 v52, 16, v135
    v_and_b32 v53, 0xffff0000, v135
    v_fmac_f32 v42, v52, v21
    v_fmac_f32 v43, v53, v21
    v_lshlrev_b32 v52, 16, v136
    v_and_b32 v53, 0xffff0000, v136
    v_fmac_f32 v36, v52, v22
    v_fmac_f32 v37, v53, v22
    v_lshlrev_b32 v52, 16, v137
    v_and_b32 v53, 0xffff0000, v137
    v_fmac_f32 v38, v52, v22
    v_fmac_f32 v39, v53, v22
    v_lshlrev_b32 v52, 16, v138
    v_and_b32 v53, 0xffff0000, v138
    v_fmac_f32 v40, v52, v22
    v_fmac_f32 v41, v53, v22
    v_lshlrev_b32 v52, 16, v139
    v_and_b32 v53, 0xffff0000, v139
    v_fmac_f32 v42, v52, v22
    v_fmac_f32 v43, v53, v22
    v_lshlrev_b32 v52, 16, v140
    v_and_b32 v53, 0xffff0000, v140
    v_fmac_f32 v36, v52, v23
    v_fmac_f32 v37, v53, v23
    v_lshlrev_b32 v52, 16, v141
    v_and_b32 v53, 0xffff0000, v141
    v_fmac_f32 v38, v52, v23
    v_fmac_f32 v39, v53, v23
    v_lshlrev_b32 v52, 16, v142
    v_and_b32 v53, 0xffff0000, v142
    v_fmac_f32 v40, v52, v23
    v_fmac_f32 v41, v53, v23
    v_lshlrev_b32 v52, 16, v143
    v_and_b32 v53, 0xffff0000, v143
    v_fmac_f32 v42, v52, v23
    v_fmac_f32 v43, v53, v23
    v_lshlrev_b32 v52, 16, v144
    v_and_b32 v53, 0xffff0000, v144
    v_fmac_f32 v36, v52, v24
    v_fmac_f32 v37, v53, v24
    v_lshlrev_b32 v52, 16, v145
    v_and_b32 v53, 0xffff0000, v145
    v_fmac_f32 v38, v52, v24
    v_fmac_f32 v39, v53, v24
    v_lshlrev_b32 v52, 16, v146
    v_and_b32 v53, 0xffff0000, v146
    v_fmac_f32 v40, v52, v24
    v_fmac_f32 v41, v53, v24
    v_lshlrev_b32 v52, 16, v147
    v_and_b32 v53, 0xffff0000, v147
    v_fmac_f32 v42, v52, v24
    v_fmac_f32 v43, v53, v24
    v_lshlrev_b32 v52, 16, v148
    v_and_b32 v53, 0xffff0000, v148
    v_fmac_f32 v36, v52, v25
    v_fmac_f32 v37, v53, v25
    v_lshlrev_b32 v52, 16, v149
    v_and_b32 v53, 0xffff0000, v149
    v_fmac_f32 v38, v52, v25
    v_fmac_f32 v39, v53, v25
    v_lshlrev_b32 v52, 16, v150
    v_and_b32 v53, 0xffff0000, v150
    v_fmac_f32 v40, v52, v25
    v_fmac_f32 v41, v53, v25
    v_lshlrev_b32 v52, 16, v151
    v_and_b32 v53, 0xffff0000, v151
    v_fmac_f32 v42, v52, v25
    v_fmac_f32 v43, v53, v25
    v_lshlrev_b32 v52, 16, v152
    v_and_b32 v53, 0xffff0000, v152
    v_fmac_f32 v36, v52, v26
    v_fmac_f32 v37, v53, v26
    v_lshlrev_b32 v52, 16, v153
    v_and_b32 v53, 0xffff0000, v153
    v_fmac_f32 v38, v52, v26
    v_fmac_f32 v39, v53, v26
    v_lshlrev_b32 v52, 16, v154
    v_and_b32 v53, 0xffff0000, v154
    v_fmac_f32 v40, v52, v26
    v_fmac_f32 v41, v53, v26
    v_lshlrev_b32 v52, 16, v155
    v_and_b32 v53, 0xffff0000, v155
    v_fmac_f32 v42, v52, v26
    v_fmac_f32 v43, v53, v26
    v_lshlrev_b32 v1, 8, v10
    v_lshl_add_u32 v1, v11, 5, v1
    v_add_u32 v1, s11, v1
    ds_write_b128 v1, v[36:39]
    ds_write_b128 v1, v[40:43] offset:16
    s_waitcnt lgkmcnt(0)
    v_lshlrev_b32 v1, 2, v0
    v_add_u32 v1, s11, v1
    ds_read_b32 v20, v1 offset:0
    ds_read_b32 v21, v1 offset:256
    ds_read_b32 v22, v1 offset:512
    ds_read_b32 v23, v1 offset:768
    ds_read_b32 v24, v1 offset:1024
    ds_read_b32 v25, v1 offset:1280
    ds_read_b32 v26, v1 offset:1536
    ds_read_b32 v27, v1 offset:1792
    s_waitcnt lgkmcnt(0)
    v_add_f32 v20, v20, v21
    v_add_f32 v20, v20, v22
    v_add_f32 v20, v20, v23
    v_add_f32 v20, v20, v24
    v_add_f32 v20, v20, v25
    v_add_f32 v20, v20, v26
    v_add_f32 v20, v20, v27
    ds_write_b32 v1, v20 offset:2560
    s_waitcnt lgkmcnt(0)
    ds_read_b32 v4, v1 offset:2560
    ds_read_b32 v5, v1 offset:2624
    ds_read_b32 v6, v1 offset:2688
    ds_read_b32 v7, v1 offset:2752
    s_waitcnt lgkmcnt(0)
    v_add_u32 v4, 0x80, v4
    v_bfi_b32 v4, v15, s16, v4
    v_add_u32 v5, 0x80, v5
    v_bfi_b32 v5, v15, s17, v5
    v_add_u32 v6, 0x80, v6
    v_bfi_b32 v6, v15, s18, v6
    v_add_u32 v7, 0x80, v7
    v_bfi_b32 v7, v15, s19, v7
    v_lshlrev_b32 v1, 4, v0
    s_lshl_b32 s88, s2, 9
    s_lshl_b32 s91, s89, 8
    s_add_u32 s88, s88, s91
    s_add_u32 s88, s88, 1163264
    s_mov_b64 exec, 0xffff
    buffer_store_dwordx4 v[4:7], v1, s[80:83], s88 offen sc1
    s_branch L_end
L_stream:
    s_sub_u32 s4, s3, 4
    s_lshr_b32 s88, s2, 5
    s_bfe_u32 s89, s2, 0x10004
    s_lshl_b32 s89, s89, 3
    s_add_u32 s88, s88, s89
    s_lshl_b32 s5, s88, 23
    s_and_b32 s88, s2, 15
    s_lshl_b32 s88, s88, 16
    s_add_u32 s5, s5, s88
    s_lshl_b32 s6, s4, 14
    s_lshl_b32 s88, s4, 10
    s_add_u32 s5, s5, s88
    s_add_u32 s5, s5, 7340032
    v_lshrrev_b32 v1, 4, v0
    v_and_b32 v2, 15, v0
    v_add_u32 v3, 0, v1
    v_xor_b32 v3, v3, v2
    v_lshlrev_b32 v3, 4, v3
    v_lshl_add_u32 v4, v1, 8, v3
    v_add_u32 v3, 4, v1
    v_xor_b32 v3, v3, v2
    v_lshlrev_b32 v3, 4, v3
    v_lshl_add_u32 v5, v1, 8, v3
    v_add_u32 v3, 8, v1
    v_xor_b32 v3, v3, v2
    v_lshlrev_b32 v3, 4, v3
    v_lshl_add_u32 v6, v1, 8, v3
    v_add_u32 v3, 12, v1
    v_xor_b32 v3, v3, v2
    v_lshlrev_b32 v3, 4, v3
    v_lshl_add_u32 v7, v1, 8, v3
    v_add_u32 v3, 0, v1
    v_lshlrev_b32 v3, 1, v3
    v_xor_b32 v3, v3, v2
    v_lshlrev_b32 v3, 4, v3
    v_lshl_add_u32 v8, v1, 8, v3
    v_add_u32 v3, 4, v1
    v_lshlrev_b32 v3, 1, v3
    v_xor_b32 v3, v3, v2
    v_lshlrev_b32 v3, 4, v3
    v_lshl_add_u32 v9, v1, 8, v3
    s_mov_b32 s88, s5
    s_add_u32 s89, s6, 0
    s_mov_b32 m0, s89
    s_nop 0
    buffer_load_dwordx4 v4, s[44:47], s88 offen nt lds
    s_add_u32 s88, s88, 4096
    s_add_u32 s89, s89, 1024
    s_mov_b32 m0, s89
    s_nop 0
    buffer_load_dwordx4 v5, s[44:47], s88 offen nt lds
    s_add_u32 s88, s88, 4096
    s_add_u32 s89, s89, 1024
    s_mov_b32 m0, s89
    s_nop 0
    buffer_load_dwordx4 v6, s[44:47], s88 offen nt lds
    s_add_u32 s88, s88, 4096
    s_add_u32 s89, s89, 1024
    s_mov_b32 m0, s89
    s_nop 0
    buffer_load_dwordx4 v7, s[44:47], s88 offen nt lds
    s_add_u32 s88, s88, 4096
    s_add_u32 s89, s89, 1024
    s_mov_b32 m0, s89
    s_nop 0
    buffer_load_dwordx4 v4, s[44:47], s88 offen nt lds
    s_add_u32 s88, s88, 4096
    s_add_u32 s89, s89, 1024
    s_mov_b32 m0, s89
    s_nop 0
    buffer_load_dwordx4 v5, s[44:47], s88 offen nt lds
    s_add_u32 s88, s88, 4096
    s_add_u32 s89, s89, 1024
    s_mov_b32 m0, s89
    s_nop 0
    buffer_load_dwordx4 v6, s[44:47], s88 offen nt lds
    s_add_u32 s88, s88, 4096
    s_add_u32 s89, s89, 1024
    s_mov_b32 m0, s89
    s_nop 0
    buffer_load_dwordx4 v7, s[44:47], s88 offen nt lds
    s_add_u32 s88, s88, 4096
    s_add_u32 s89, s89, 1024
    s_mov_b32 m0, s89
    s_nop 0
    buffer_load_dwordx4 v4, s[44:47], s88 offen nt lds
    s_add_u32 s88, s88, 4096
    s_add_u32 s89, s89, 1024
    s_mov_b32 m0, s89
    s_nop 0
    buffer_load_dwordx4 v5, s[44:47], s88 offen nt lds
    s_add_u32 s88, s88, 4096
    s_add_u32 s89, s89, 1024
    s_mov_b32 m0, s89
    s_nop 0
    buffer_load_dwordx4 v6, s[44:47], s88 offen nt lds
    s_add_u32 s88, s88, 4096
    s_add_u32 s89, s89, 1024
    s_mov_b32 m0, s89
    s_nop 0
    buffer_load_dwordx4 v7, s[44:47], s88 offen nt lds
    s_add_u32 s88, s88, 4096
    s_add_u32 s89, s89, 1024
    s_mov_b32 m0, s89
    s_nop 0
    buffer_load_dwordx4 v4, s[44:47], s88 offen nt lds
    s_add_u32 s88, s88, 4096
    s_add_u32 s89, s89, 1024
    s_mov_b32 m0, s89
    s_nop 0
    buffer_load_dwordx4 v5, s[44:47], s88 offen nt lds
    s_add_u32 s88, s88, 4096
    s_add_u32 s89, s89, 1024
    s_mov_b32 m0, s89
    s_nop 0
    buffer_load_dwordx4 v6, s[44:47], s88 offen nt lds
    s_add_u32 s88, s88, 4096
    s_add_u32 s89, s89, 1024
    s_mov_b32 m0, s89
    s_nop 0
    buffer_load_dwordx4 v7, s[44:47], s88 offen nt lds
    s_add_u32 s88, s88, 4096
    s_add_u32 s89, s89, 1024
    s_mov_b32 s88, s5
    s_add_u32 s89, s6, 65536
    s_mov_b32 m0, s89
    s_nop 0
    buffer_load_dwordx4 v8, s[48:51], s88 offen nt lds
    s_add_u32 s88, s88, 4096
    s_add_u32 s89, s89, 1024
    s_mov_b32 m0, s89
    s_nop 0
    buffer_load_dwordx4 v9, s[48:51], s88 offen nt lds
    s_add_u32 s88, s88, 4096
    s_add_u32 s89, s89, 1024
    s_mov_b32 m0, s89
    s_nop 0
    buffer_load_dwordx4 v8, s[48:51], s88 offen nt lds
    s_add_u32 s88, s88, 4096
    s_add_u32 s89, s89, 1024
    s_mov_b32 m0, s89
    s_nop 0
    buffer_load_dwordx4 v9, s[48:51], s88 offen nt lds
    s_add_u32 s88, s88, 4096
    s_add_u32 s89, s89, 1024
    s_mov_b32 m0, s89
    s_nop 0
    buffer_load_dwordx4 v8, s[48:51], s88 offen nt lds
    s_add_u32 s88, s88, 4096
    s_add_u32 s89, s89, 1024
    s_mov_b32 m0, s89
    s_nop 0
    buffer_load_dwordx4 v9, s[48:51], s88 offen nt lds
    s_add_u32 s88, s88, 4096
    s_add_u32 s89, s89, 1024
    s_mov_b32 m0, s89
    s_nop 0
    buffer_load_dwordx4 v8, s[48:51], s88 offen nt lds
    s_add_u32 s88, s88, 4096
    s_add_u32 s89, s89, 1024
    s_mov_b32 m0, s89
    s_nop 0
    buffer_load_dwordx4 v9, s[48:51], s88 offen nt lds
    s_add_u32 s88, s88, 4096
    s_add_u32 s89, s89, 1024
    s_mov_b32 m0, s89
    s_nop 0
    buffer_load_dwordx4 v8, s[48:51], s88 offen nt lds
    s_add_u32 s88, s88, 4096
    s_add_u32 s89, s89, 1024
    s_mov_b32 m0, s89
    s_nop 0
    buffer_load_dwordx4 v9, s[48:51], s88 offen nt lds
    s_add_u32 s88, s88, 4096
    s_add_u32 s89, s89, 1024
    s_mov_b32 m0, s89
    s_nop 0
    buffer_load_dwordx4 v8, s[48:51], s88 offen nt lds
    s_add_u32 s88, s88, 4096
    s_add_u32 s89, s89, 1024
    s_mov_b32 m0, s89
    s_nop 0
    buffer_load_dwordx4 v9, s[48:51], s88 offen nt lds
    s_add_u32 s88, s88, 4096
    s_add_u32 s89, s89, 1024
    s_mov_b32 m0, s89
    s_nop 0
    buffer_load_dwordx4 v8, s[48:51], s88 offen nt lds
    s_add_u32 s88, s88, 4096
    s_add_u32 s89, s89, 1024
    s_mov_b32 m0, s89
    s_nop 0
    buffer_load_dwordx4 v9, s[48:51], s88 offen nt lds
    s_add_u32 s88, s88, 4096
    s_add_u32 s89, s89, 1024
    s_mov_b32 m0, s89
    s_nop 0
    buffer_load_dwordx4 v8, s[48:51], s88 offen nt lds
    s_add_u32 s88, s88, 4096
    s_add_u32 s89, s89, 1024
    s_mov_b32 m0, s89
    s_nop 0
    buffer_load_dwordx4 v9, s[48:51], s88 offen nt lds
    v_mov_b32 v17, 153088
    s_mov_b32 s93, 0
L_rn_str0:
    ds_read_b32 v16, v17
    s_waitcnt lgkmcnt(0)
    v_readfirstlane_b32 s92, v16
    s_add_u32 s93, s93, 1
    s_cmp_lg_u32 s92, 0
    s_cbranch_scc1 L_rn_str0_ok
    s_cmp_lt_u32 s93, 3200000
    s_cbranch_scc1 L_rn_str0
L_rn_str0_ok:
    s_bfe_u32 s16, s92, 524288
    s_bfe_u32 s17, s92, 524296
    s_bfe_u32 s18, s92, 524304
    s_bfe_u32 s19, s92, 524312
    v_mov_b32 v17, 153124
    v_mov_b32 v16, s92
    ds_write_b32 v17, v16
    s_add_u32 s88, s88, 4096
    s_add_u32 s89, s89, 1024
    v_mov_b32 v17, 153088
    s_mov_b32 s93, 0
L_rn_str:
    ds_read_b32 v16, v17
    s_waitcnt lgkmcnt(0)
    v_readfirstlane_b32 s92, v16
    s_add_u32 s93, s93, 1
    s_cmp_lg_u32 s92, 0
    s_cbranch_scc1 L_rn_str_ok
    s_cmp_lt_u32 s93, 3200000
    s_cbranch_scc1 L_rn_str
L_rn_str_ok:
    s_bfe_u32 s16, s92, 524288
    s_bfe_u32 s17, s92, 524296
    s_bfe_u32 s18, s92, 524304
    s_bfe_u32 s19, s92, 524312
    v_add_u32 v3, 0, v1
    v_xor_b32 v3, v3, v2
    v_lshlrev_b32 v3, 4, v3
    v_lshl_add_u32 v3, v2, 8, v3
    v_add_u32 v10, s6, v3
    v_add_u32 v3, 4, v1
    v_xor_b32 v3, v3, v2
    v_lshlrev_b32 v3, 4, v3
    v_lshl_add_u32 v3, v2, 8, v3
    v_add_u32 v11, s6, v3
    v_add_u32 v3, 8, v1
    v_xor_b32 v3, v3, v2
    v_lshlrev_b32 v3, 4, v3
    v_lshl_add_u32 v3, v2, 8, v3
    v_add_u32 v12, s6, v3
    v_add_u32 v3, 12, v1
    v_xor_b32 v3, v3, v2
    v_lshlrev_b32 v3, 4, v3
    v_lshl_add_u32 v3, v2, 8, v3
    v_add_u32 v13, s6, v3
    v_bfe_u32 v14, v0, 2, 2
    v_and_b32 v19, 3, v0
    v_lshl_add_u32 v16, v1, 2, v14
    v_and_b32 v17, 7, v16
    v_lshlrev_b32 v16, 8, v16
    v_lshl_add_u32 v16, v19, 3, v16
    v_add_u32 v16, s6, v16
    v_add_u32 v16, 65536, v16
    v_xor_b32 v3, 0, v17
    v_lshl_add_u32 v20, v3, 5, v16
    v_xor_b32 v3, 1, v17
    v_lshl_add_u32 v21, v3, 5, v16
    v_xor_b32 v3, 2, v17
    v_lshl_add_u32 v22, v3, 5, v16
    v_xor_b32 v3, 3, v17
    v_lshl_add_u32 v23, v3, 5, v16
    v_xor_b32 v3, 4, v17
    v_lshl_add_u32 v24, v3, 5, v16
    v_xor_b32 v3, 5, v17
    v_lshl_add_u32 v25, v3, 5, v16
    v_xor_b32 v3, 6, v17
    v_lshl_add_u32 v26, v3, 5, v16
    v_xor_b32 v3, 7, v17
    v_lshl_add_u32 v27, v3, 5, v16
    v_and_b32 v3, 3, v2
    v_lshlrev_b32 v3, 8, v3
    v_lshl_add_u32 v3, v1, 4, v3
    v_add_u32 v18, 151552, v3
    s_waitcnt vmcnt(16)
    ds_read_b128 v[64:67], v10 offset:0
    ds_read_b128 v[68:71], v11 offset:0
    ds_read_b128 v[72:75], v12 offset:0
    ds_read_b128 v[76:79], v13 offset:0
    ds_read_b128 v[80:83], v10 offset:4096
    ds_read_b128 v[84:87], v11 offset:4096
    ds_read_b128 v[88:91], v12 offset:4096
    ds_read_b128 v[92:95], v13 offset:4096
    ds_read_b128 v[96:99], v10 offset:8192
    ds_read_b128 v[100:103], v11 offset:8192
    ds_read_b128 v[104:107], v12 offset:8192
    ds_read_b128 v[108:111], v13 offset:8192
    ds_read_b128 v[112:115], v10 offset:12288
    ds_read_b128 v[116:119], v11 offset:12288
    ds_read_b128 v[120:123], v12 offset:12288
    ds_read_b128 v[124:127], v13 offset:12288
    s_waitcnt vmcnt(0)
    ds_read_b64_tr_b16 v[128:129], v20 offset:0
    ds_read_b64_tr_b16 v[130:131], v20 offset:4096
    ds_read_b64_tr_b16 v[132:133], v21 offset:0
    ds_read_b64_tr_b16 v[134:135], v21 offset:4096
    ds_read_b64_tr_b16 v[136:137], v22 offset:0
    ds_read_b64_tr_b16 v[138:139], v22 offset:4096
    ds_read_b64_tr_b16 v[140:141], v23 offset:0
    ds_read_b64_tr_b16 v[142:143], v23 offset:4096
    ds_read_b64_tr_b16 v[144:145], v24 offset:0
    ds_read_b64_tr_b16 v[146:147], v24 offset:4096
    ds_read_b64_tr_b16 v[148:149], v25 offset:0
    ds_read_b64_tr_b16 v[150:151], v25 offset:4096
    ds_read_b64_tr_b16 v[152:153], v26 offset:0
    ds_read_b64_tr_b16 v[154:155], v26 offset:4096
    ds_read_b64_tr_b16 v[156:157], v27 offset:0
    ds_read_b64_tr_b16 v[158:159], v27 offset:4096
    ds_read_b64_tr_b16 v[160:161], v20 offset:8192
    ds_read_b64_tr_b16 v[162:163], v20 offset:12288
    ds_read_b64_tr_b16 v[164:165], v21 offset:8192
    ds_read_b64_tr_b16 v[166:167], v21 offset:12288
    ds_read_b64_tr_b16 v[168:169], v22 offset:8192
    ds_read_b64_tr_b16 v[170:171], v22 offset:12288
    ds_read_b64_tr_b16 v[172:173], v23 offset:8192
    ds_read_b64_tr_b16 v[174:175], v23 offset:12288
    ds_read_b64_tr_b16 v[176:177], v24 offset:8192
    ds_read_b64_tr_b16 v[178:179], v24 offset:12288
    ds_read_b64_tr_b16 v[180:181], v25 offset:8192
    ds_read_b64_tr_b16 v[182:183], v25 offset:12288
    ds_read_b64_tr_b16 v[184:185], v26 offset:8192
    ds_read_b64_tr_b16 v[186:187], v26 offset:12288
    ds_read_b64_tr_b16 v[188:189], v27 offset:8192
    ds_read_b64_tr_b16 v[190:191], v27 offset:12288
    v_mov_b32 v5, 153128
    s_mov_b32 s90, 0
L_qw:
    ds_read_b64 v[32:33], v5
    s_waitcnt lgkmcnt(0)
    v_xor_b32 v32, s92, v32
    v_xor_b32 v33, s92, v33
    v_or_b32 v32, v32, v33
    v_cmp_ne_u32 vcc, 0, v32
    s_nop 4
    s_cbranch_vccz L_qw_ok
    s_sleep 1
    s_add_u32 s90, s90, 1
    s_cmp_lt_u32 s90, 3200000
    s_cbranch_scc1 L_qw
L_qw_ok:
    ds_read_b128 v[32:35], v18 offset:0
    ds_read_b128 v[36:39], v18 offset:64
    ds_read_b128 v[40:43], v18 offset:128
    ds_read_b128 v[44:47], v18 offset:192
    s_waitcnt lgkmcnt(0)
    v_mfma_f32_16x16x32_bf16 v[48:51], v[64:67], v[32:35], 0
    v_mfma_f32_16x16x32_bf16 v[48:51], v[68:71], v[36:39], v[48:51]
    v_mfma_f32_16x16x32_bf16 v[48:51], v[72:75], v[40:43], v[48:51]
    v_mfma_f32_16x16x32_bf16 v[48:51], v[76:79], v[44:47], v[48:51]
    v_mfma_f32_16x16x32_bf16 v[52:55], v[80:83], v[32:35], 0
    v_mfma_f32_16x16x32_bf16 v[52:55], v[84:87], v[36:39], v[52:55]
    v_mfma_f32_16x16x32_bf16 v[52:55], v[88:91], v[40:43], v[52:55]
    v_mfma_f32_16x16x32_bf16 v[52:55], v[92:95], v[44:47], v[52:55]
    v_mfma_f32_16x16x32_bf16 v[56:59], v[96:99], v[32:35], 0
    v_mfma_f32_16x16x32_bf16 v[56:59], v[100:103], v[36:39], v[56:59]
    v_mfma_f32_16x16x32_bf16 v[56:59], v[104:107], v[40:43], v[56:59]
    v_mfma_f32_16x16x32_bf16 v[56:59], v[108:111], v[44:47], v[56:59]
    v_mfma_f32_16x16x32_bf16 v[60:63], v[112:115], v[32:35], 0
    v_mfma_f32_16x16x32_bf16 v[60:63], v[116:119], v[36:39], v[60:63]
    v_mfma_f32_16x16x32_bf16 v[60:63], v[120:123], v[40:43], v[60:63]
    v_mfma_f32_16x16x32_bf16 v[60:63], v[124:127], v[44:47], v[60:63]
    s_nop 7
    s_nop 1
    s_mov_b32 s88, 0x3db504f3
    v_cvt_pk_bf16_f32 v3, v48, v49
    v_lshlrev_b32 v48, 16, v3
    v_and_b32 v49, 0xffff0000, v3
    v_mul_f32 v48, s88, v48
    v_mul_f32 v49, s88, v49
    v_cvt_pk_bf16_f32 v3, v48, v49
    v_lshlrev_b32 v48, 16, v3
    v_and_b32 v49, 0xffff0000, v3
    v_cvt_pk_bf16_f32 v3, v50, v51
    v_lshlrev_b32 v50, 16, v3
    v_and_b32 v51, 0xffff0000, v3
    v_mul_f32 v50, s88, v50
    v_mul_f32 v51, s88, v51
    v_cvt_pk_bf16_f32 v3, v50, v51
    v_lshlrev_b32 v50, 16, v3
    v_and_b32 v51, 0xffff0000, v3
    v_cvt_pk_bf16_f32 v3, v52, v53
    v_lshlrev_b32 v52, 16, v3
    v_and_b32 v53, 0xffff0000, v3
    v_mul_f32 v52, s88, v52
    v_mul_f32 v53, s88, v53
    v_cvt_pk_bf16_f32 v3, v52, v53
    v_lshlrev_b32 v52, 16, v3
    v_and_b32 v53, 0xffff0000, v3
    v_cvt_pk_bf16_f32 v3, v54, v55
    v_lshlrev_b32 v54, 16, v3
    v_and_b32 v55, 0xffff0000, v3
    v_mul_f32 v54, s88, v54
    v_mul_f32 v55, s88, v55
    v_cvt_pk_bf16_f32 v3, v54, v55
    v_lshlrev_b32 v54, 16, v3
    v_and_b32 v55, 0xffff0000, v3
    v_cvt_pk_bf16_f32 v3, v56, v57
    v_lshlrev_b32 v56, 16, v3
    v_and_b32 v57, 0xffff0000, v3
    v_mul_f32 v56, s88, v56
    v_mul_f32 v57, s88, v57
    v_cvt_pk_bf16_f32 v3, v56, v57
    v_lshlrev_b32 v56, 16, v3
    v_and_b32 v57, 0xffff0000, v3
    v_cvt_pk_bf16_f32 v3, v58, v59
    v_lshlrev_b32 v58, 16, v3
    v_and_b32 v59, 0xffff0000, v3
    v_mul_f32 v58, s88, v58
    v_mul_f32 v59, s88, v59
    v_cvt_pk_bf16_f32 v3, v58, v59
    v_lshlrev_b32 v58, 16, v3
    v_and_b32 v59, 0xffff0000, v3
    v_cvt_pk_bf16_f32 v3, v60, v61
    v_lshlrev_b32 v60, 16, v3
    v_and_b32 v61, 0xffff0000, v3
    v_mul_f32 v60, s88, v60
    v_mul_f32 v61, s88, v61
    v_cvt_pk_bf16_f32 v3, v60, v61
    v_lshlrev_b32 v60, 16, v3
    v_and_b32 v61, 0xffff0000, v3
    v_cvt_pk_bf16_f32 v3, v62, v63
    v_lshlrev_b32 v62, 16, v3
    v_and_b32 v63, 0xffff0000, v3
    v_mul_f32 v62, s88, v62
    v_mul_f32 v63, s88, v63
    v_cvt_pk_bf16_f32 v3, v62, v63
    v_lshlrev_b32 v62, 16, v3
    v_and_b32 v63, 0xffff0000, v3
    v_max3_f32 v28, v48, v49, v50
    v_max3_f32 v28, v28, v51, v52
    v_max3_f32 v28, v28, v53, v54
    v_max3_f32 v28, v28, v55, v56
    v_max3_f32 v28, v28, v57, v58
    v_max3_f32 v28, v28, v59, v60
    v_max3_f32 v28, v28, v61, v62
    v_max_f32 v28, v28, v63
    v_mov_b32 v29, v28
    s_nop 1
    v_permlane16_swap_b32 v28, v29
    s_nop 1
    v_max_f32 v28, v28, v29
    v_mov_b32 v29, v28
    s_nop 1
    v_permlane32_swap_b32 v28, v29
    s_nop 1
    v_max_f32 v28, v28, v29
    s_mov_b32 s88, 0x3fb8aa3b
    v_mul_f32 v30, s88, v28
    v_fma_f32 v48, v48, s88, -v30
    v_fma_f32 v49, v49, s88, -v30
    v_fma_f32 v50, v50, s88, -v30
    v_fma_f32 v51, v51, s88, -v30
    v_fma_f32 v52, v52, s88, -v30
    v_fma_f32 v53, v53, s88, -v30
    v_fma_f32 v54, v54, s88, -v30
    v_fma_f32 v55, v55, s88, -v30
    v_fma_f32 v56, v56, s88, -v30
    v_fma_f32 v57, v57, s88, -v30
    v_fma_f32 v58, v58, s88, -v30
    v_fma_f32 v59, v59, s88, -v30
    v_fma_f32 v60, v60, s88, -v30
    v_fma_f32 v61, v61, s88, -v30
    v_fma_f32 v62, v62, s88, -v30
    v_fma_f32 v63, v63, s88, -v30
    v_exp_f32 v48, v48
    v_exp_f32 v49, v49
    v_exp_f32 v50, v50
    v_exp_f32 v51, v51
    v_exp_f32 v52, v52
    v_exp_f32 v53, v53
    v_exp_f32 v54, v54
    v_exp_f32 v55, v55
    v_exp_f32 v56, v56
    v_exp_f32 v57, v57
    v_exp_f32 v58, v58
    v_exp_f32 v59, v59
    v_exp_f32 v60, v60
    v_exp_f32 v61, v61
    v_exp_f32 v62, v62
    v_exp_f32 v63, v63
    s_nop 0
    v_add_f32 v29, v48, v49
    v_add_f32 v29, v29, v50
    v_add_f32 v29, v29, v51
    v_add_f32 v29, v29, v52
    v_add_f32 v29, v29, v53
    v_add_f32 v29, v29, v54
    v_add_f32 v29, v29, v55
    v_add_f32 v29, v29, v56
    v_add_f32 v29, v29, v57
    v_add_f32 v29, v29, v58
    v_add_f32 v29, v29, v59
    v_add_f32 v29, v29, v60
    v_add_f32 v29, v29, v61
    v_add_f32 v29, v29, v62
    v_add_f32 v29, v29, v63
    v_mov_b32 v30, v29
    s_nop 1
    v_permlane16_swap_b32 v29, v30
    s_nop 1
    v_add_f32 v29, v29, v30
    v_mov_b32 v30, v29
    s_nop 1
    v_permlane32_swap_b32 v29, v30
    s_nop 1
    v_add_f32 v29, v29, v30
    v_cvt_pk_bf16_f32 v32, v48, v49
    v_cvt_pk_bf16_f32 v33, v50, v51
    v_cvt_pk_bf16_f32 v34, v52, v53
    v_cvt_pk_bf16_f32 v35, v54, v55
    v_cvt_pk_bf16_f32 v36, v56, v57
    v_cvt_pk_bf16_f32 v37, v58, v59
    v_cvt_pk_bf16_f32 v38, v60, v61
    v_cvt_pk_bf16_f32 v39, v62, v63
    s_nop 1
    v_mfma_f32_16x16x32_bf16 v[192:195], v[32:35], v[128:131], 0
    v_mfma_f32_16x16x32_bf16 v[196:199], v[32:35], v[132:135], 0
    v_mfma_f32_16x16x32_bf16 v[200:203], v[32:35], v[136:139], 0
    v_mfma_f32_16x16x32_bf16 v[204:207], v[32:35], v[140:143], 0
    v_mfma_f32_16x16x32_bf16 v[208:211], v[32:35], v[144:147], 0
    v_mfma_f32_16x16x32_bf16 v[212:215], v[32:35], v[148:151], 0
    v_mfma_f32_16x16x32_bf16 v[216:219], v[32:35], v[152:155], 0
    v_mfma_f32_16x16x32_bf16 v[220:223], v[32:35], v[156:159], 0
    v_mfma_f32_16x16x32_bf16 v[192:195], v[36:39], v[160:163], v[192:195]
    v_mfma_f32_16x16x32_bf16 v[196:199], v[36:39], v[164:167], v[196:199]
    v_mfma_f32_16x16x32_bf16 v[200:203], v[36:39], v[168:171], v[200:203]
    v_mfma_f32_16x16x32_bf16 v[204:207], v[36:39], v[172:175], v[204:207]
    v_mfma_f32_16x16x32_bf16 v[208:211], v[36:39], v[176:179], v[208:211]
    v_mfma_f32_16x16x32_bf16 v[212:215], v[36:39], v[180:183], v[212:215]
    v_mfma_f32_16x16x32_bf16 v[216:219], v[36:39], v[184:187], v[216:219]
    v_mfma_f32_16x16x32_bf16 v[220:223], v[36:39], v[188:191], v[220:223]
    s_nop 7
    s_nop 1
    v_lshlrev_b32 v3, 4, v0
    v_add_u32 v3, s6, v3
    v_lshlrev_b32 v4, 3, v0
    v_add_u32 v4, s6, v4
    s_mov_b64 exec, 0xffff
    ds_write_b128 v3, v[192:195] offset:0
    ds_write_b128 v3, v[196:199] offset:256
    ds_write_b128 v3, v[200:203] offset:512
    ds_write_b128 v3, v[204:207] offset:768
    ds_write_b128 v3, v[208:211] offset:1024
    ds_write_b128 v3, v[212:215] offset:1280
    ds_write_b128 v3, v[216:219] offset:1536
    ds_write_b128 v3, v[220:223] offset:1792
    s_mov_b64 exec, 15
    ds_write_b64 v4, v[28:29] offset:2048
    s_mov_b64 exec, -1
    v_mov_b32 v4, s92
    s_lshl_b32 s88, s4, 2
    s_add_u32 s88, s88, 153104
    v_mov_b32 v5, s88
    s_waitcnt lgkmcnt(0)
    ds_write_b32 v5, v4
    v_mov_b32 v5, 153104
    s_mov_b32 s90, 0
L_sf:
    ds_read_b128 v[32:35], v5
    s_waitcnt lgkmcnt(0)
    v_xor_b32 v32, v32, v4
    v_xor_b32 v33, v33, v4
    v_xor_b32 v34, v34, v4
    v_xor_b32 v35, v35, v4
    v_or3_b32 v32, v32, v33, v34
    v_or_b32 v32, v32, v35
    v_cmp_ne_u32 vcc, 0, v32
    s_nop 4
    s_cbranch_vccz L_sf_ok
    s_add_u32 s90, s90, 1
    s_cmp_lt_u32 s90, 3200000
    s_cbranch_scc1 L_sf
L_sf_ok:
    s_lshl_b32 s88, s4, 2
    v_and_b32 v5, 31, v0
    v_lshlrev_b32 v3, 4, v5
    v_add_u32 v3, s88, v3
    s_lshl_b32 s88, s4, 3
    v_mov_b32 v4, s88
    ds_read2st64_b32 v[32:33], v3 offset0:0 offset1:2
    ds_read2st64_b32 v[34:35], v3 offset0:4 offset1:6
    ds_read_b64 v[64:65], v4 offset:2048
    ds_read2st64_b32 v[36:37], v3 offset0:64 offset1:66
    ds_read2st64_b32 v[38:39], v3 offset0:68 offset1:70
    ds_read_b64 v[66:67], v4 offset:18432
    ds_read2st64_b32 v[40:41], v3 offset0:128 offset1:130
    ds_read2st64_b32 v[42:43], v3 offset0:132 offset1:134
    ds_read_b64 v[68:69], v4 offset:34816
    ds_read2st64_b32 v[44:45], v3 offset0:192 offset1:194
    ds_read2st64_b32 v[46:47], v3 offset0:196 offset1:198
    ds_read_b64 v[70:71], v4 offset:51200
    s_waitcnt lgkmcnt(0)
    v_mov_b32 v50, v64
    v_mov_b32 v54, v65
    v_mov_b32 v51, v66
    v_mov_b32 v55, v67
    v_mov_b32 v52, v68
    v_mov_b32 v56, v69
    v_mov_b32 v53, v70
    v_mov_b32 v57, v71
    v_max3_f32 v58, v50, v51, v52
    v_max_f32 v58, v58, v53
    s_mov_b32 s88, 0x3fb8aa3b
    v_sub_f32 v50, v50, v58
    v_mul_f32 v50, s88, v50
    v_exp_f32 v50, v50
    v_sub_f32 v51, v51, v58
    v_mul_f32 v51, s88, v51
    v_exp_f32 v51, v51
    v_sub_f32 v52, v52, v58
    v_mul_f32 v52, s88, v52
    v_exp_f32 v52, v52
    v_sub_f32 v53, v53, v58
    v_mul_f32 v53, s88, v53
    v_exp_f32 v53, v53
    s_nop 0
    v_mul_f32 v60, v32, v50
    v_mul_f32 v61, v33, v50
    v_mul_f32 v62, v34, v50
    v_mul_f32 v63, v35, v50
    v_mul_f32 v59, v54, v50
    v_fmac_f32 v60, v36, v51
    v_fmac_f32 v61, v37, v51
    v_fmac_f32 v62, v38, v51
    v_fmac_f32 v63, v39, v51
    v_fmac_f32 v59, v55, v51
    v_fmac_f32 v60, v40, v52
    v_fmac_f32 v61, v41, v52
    v_fmac_f32 v62, v42, v52
    v_fmac_f32 v63, v43, v52
    v_fmac_f32 v59, v56, v52
    v_fmac_f32 v60, v44, v53
    v_fmac_f32 v61, v45, v53
    v_fmac_f32 v62, v46, v53
    v_fmac_f32 v63, v47, v53
    v_fmac_f32 v59, v57, v53
    v_cmp_gt_u32 vcc, 32, v0
    v_lshlrev_b32 v3, 4, v5
    s_nop 0
    v_cndmask_b32 v60, v58, v60, vcc
    v_cndmask_b32 v61, v59, v61, vcc
    v_cndmask_b32 v62, 0, v62, vcc
    v_cndmask_b32 v63, 0, v63, vcc
    v_mov_b32 v4, 0x200
    v_cndmask_b32 v3, v4, v3, vcc
    v_add_u32 v60, 0x80, v60
    v_bfi_b32 v60, v15, s16, v60
    v_add_u32 v61, 0x80, v61
    v_bfi_b32 v61, v15, s17, v61
    v_add_u32 v62, 0x80, v62
    v_bfi_b32 v62, v15, s18, v62
    v_add_u32 v63, 0x80, v63
    v_bfi_b32 v63, v15, s19, v63
    s_lshl_b32 s88, s2, 2
    s_add_u32 s88, s88, s4
    s_mul_i32 s88, s88, 528
    s_add_u32 s88, s88, 491520
    s_mov_b32 exec_hi, 1
    buffer_store_dwordx4 v[60:63], v3, s[80:83], s88 offen sc1
L_end:
    s_endpgm
.section .rodata,"a"
.p2align 6
.amdhsa_kernel parallel_sum__sliding_block_cached__swiglu_ffn__decode_kernel
  .amdhsa_next_free_vgpr 224
  .amdhsa_next_free_sgpr 96
  .amdhsa_accum_offset 224
  .amdhsa_group_segment_fixed_size 0
  .amdhsa_kernarg_size 96
  .amdhsa_user_sgpr_count 2
  .amdhsa_user_sgpr_kernarg_segment_ptr 1
  .amdhsa_system_sgpr_workgroup_id_x 1
.end_amdhsa_kernel
```
